```python
import torch

def _softmax(x, axis=-1):
    return torch.softmax(x, dim=axis)
def _gelu(x):
    return torch.nn.functional.gelu(x, approximate="tanh")
def _silu(x):
    return torch.nn.functional.silu(x)
def _sigmoid(x):
    return torch.sigmoid(x)
def _layernorm(x, axis=-1, eps=1e-5):
    m = x.mean(dim=axis, keepdim=True)
    v = x.var(dim=axis, keepdim=True, unbiased=False)
    return (x - m) / torch.sqrt(v + eps)
def _scatter_add(tgt, idx, src, axis=0):
    return tgt.clone().index_add_(axis, idx, src)
def _segment_sum(src, seg, n):
    out = torch.zeros((n,) + src.shape[1:], dtype=src.dtype)
    return out.index_add_(0, seg, src)
def _pad(x, pw):
    flat = tuple(v for pair in reversed(pw) for v in pair)
    return torch.nn.functional.pad(x, flat)

kernel_name = 'concat_heads__linear_kernel_hedgehog__ssm_conv_s4d__prompt'

def setup_inputs():

    _w = (lambda a: (lambda t: t.to(torch.bfloat16) if t.is_floating_point() else t)(torch.as_tensor(a)))
    def _A_setup():
        B, S, D, H = 1, 2048, 448, 16
        Dh = D // H
        return {
            "x": _w((lambda *s: torch.randn(*s, dtype=torch.bfloat16) * 0.4)(B, S, D)),
            "wqkv": _w((lambda *s: torch.randn(*s, dtype=torch.bfloat16) * 0.4)(D, 3 * D)),
            "w_phi": _w((lambda *s: torch.randn(*s, dtype=torch.bfloat16) * 0.4)(H, Dh, Dh) * (Dh ** -0.5)),
            "wo": _w((lambda *s: torch.randn(*s, dtype=torch.bfloat16) * 0.05)(D, D)),
        }
    _A_in = _A_setup()

    def _B_setup():
        Bsz, L, D, N = 1, 2048, 448, 256
        return {
            "u": _w((lambda *s: torch.randn(*s, dtype=torch.bfloat16) * 0.05)(Bsz, L, D)),
            "log_A_real": _w((lambda *s: torch.randn(*s, dtype=torch.bfloat16) * 3.2)(D, N) * 0.5),
            "A_imag": _w((lambda *s: torch.randn(*s, dtype=torch.bfloat16) * 0.2)(D, N) * 3.14),
            "C_real": _w((lambda *s: torch.randn(*s, dtype=torch.bfloat16) * 3.2)(D, N) / N ** 0.5),
            "C_imag": _w((lambda *s: torch.randn(*s, dtype=torch.bfloat16) * 3.2)(D, N) / N ** 0.5),
            "log_dt": _w((lambda *s: torch.randn(*s, dtype=torch.bfloat16) * 0.2)(D) * 0.5 - 4.0),
            "D_skip": _w((lambda *s: torch.randn(*s, dtype=torch.bfloat16) * 0.4)(D)),
        }
    _B_in = _B_setup()

    return {
        "A_x": _A_in["x"],
        "A_wqkv": _A_in["wqkv"],
        "A_w_phi": _A_in["w_phi"],
        "A_wo": _A_in["wo"],
        "B_u": _B_in["u"],
        "B_log_A_real": _B_in["log_A_real"],
        "B_A_imag": _B_in["A_imag"],
        "B_C_real": _B_in["C_real"],
        "B_C_imag": _B_in["C_imag"],
        "B_log_dt": _B_in["log_dt"],
        "B_D_skip": _B_in["D_skip"],
    }

def reference(A_x, A_wqkv, A_w_phi, A_wo, B_u, B_log_A_real, B_A_imag, B_C_real, B_C_imag, B_log_dt, B_D_skip):
    def _A_ref(x, wqkv, w_phi, wo):
        B, S, D = x.shape
        H = 16; Dh = D // H
        qkv = (lambda x, *d: x.permute(*d))((x @ wqkv).reshape(B, S, 3, H, Dh), 2, 0, 3, 1, 4)
        q, k, v = qkv[0], qkv[1], qkv[2]
        pq = torch.einsum("bhsd,hdf->bhsf", q, w_phi)
        pk = torch.einsum("bhsd,hdf->bhsf", k, w_phi)
        phi_q = torch.concatenate([_softmax(pq, axis=-1), _softmax(-pq, axis=-1)], axis=-1)
        phi_k = torch.concatenate([_softmax(pk, axis=-1), _softmax(-pk, axis=-1)], axis=-1)
        kv = torch.einsum("bhsf,bhsd->bhfd", phi_k, v)
        z  = torch.einsum("bhsf->bhf", phi_k)
        num = torch.einsum("bhqf,bhfd->bhqd", phi_q, kv)
        den = torch.einsum("bhqf,bhf->bhq", phi_q, z)[..., None] + 1e-6
        o = num / den
        return (lambda x, *d: x.permute(*d))(o, 0, 2, 1, 3).reshape(B, S, D) @ wo

    def _B_ref(u, log_A_real, A_imag, C_real, C_imag, log_dt, D_skip):
        L = u.shape[1]
        dt = torch.exp(log_dt)
        A = -torch.exp(log_A_real) + 1j * A_imag
        C = (C_real + 1j * C_imag) * dt[:, None]
        pos = (lambda x, dt: x.to(dt))(torch.arange(L), log_dt.dtype)
        P = torch.exp((A * dt[:, None])[:, :, None] * pos[None, None, :])
        K = 2.0 * torch.einsum("dn,dnl->dl", C, P).real
        L2 = 2 * L
        u_t = (lambda x, *d: x.permute(*d))(u, 0, 2, 1)
        Kf = (lambda x, *a, **k: torch.fft.rfft(x.float(), *a, **k))(K, L2)
        Uf = (lambda x, *a, **k: torch.fft.rfft(x.float(), *a, **k))(u_t, L2)
        y = (lambda x, *a, **k: torch.fft.irfft(x, *a, **k).to(torch.bfloat16))(Uf * Kf[None, :, :], L2)[:, :, :L]
        y = (lambda x, *d: x.permute(*d))(y, 0, 2, 1)
        return y + u * D_skip[None, None, :]

    a = _A_ref(A_x, A_wqkv, A_w_phi, A_wo)
    b = _B_ref(B_u, B_log_A_real, B_A_imag, B_C_real, B_C_imag, B_log_dt, B_D_skip)
    return torch.concatenate([a, b], axis=-1)
```

```asm
; @launch grid=(480,1,1) block=(256,1,1) lds=81920
.amdgcn_target "amdgcn-amd-amdhsa--gfx950"
.text
.globl concat_heads__linear_kernel_hedgehog__ssm_conv_s4d__prompt_kernel
.p2align 8
.type concat_heads__linear_kernel_hedgehog__ssm_conv_s4d__prompt_kernel,@function
concat_heads__linear_kernel_hedgehog__ssm_conv_s4d__prompt_kernel:
    s_cmp_ge_u32 s2, 480
    s_cbranch_scc1 L_end
    v_lshrrev_b32 v11, 6, v0
    v_and_b32 v0, 63, v0
    s_getpc_b64 s[10:11]
L_pc:
    s_load_dwordx4 s[24:27], s[0:1], 96
    v_readfirstlane_b32 s58, v11
    s_lshr_b32 s74, s2, 3
    s_lshl_b32 s75, s58, 8
    s_or_b32 s75, s75, s74
    s_cmp_ge_u32 s75, 4
    s_cbranch_scc1 L_nopf
    s_lshl_b32 s74, s74, 13
    v_lshl_add_u32 v12, v0, 7, s74
    v_min_u32 v12, L_code_end-L_pc-4, v12
    global_load_dword v13, v12, s[10:11]
L_nopf:
    s_cmp_ge_u32 s2, 256
    s_cbranch_scc1 L_B
    s_setprio 2
    s_load_dwordx4 s[4:7], s[0:1], 0
    s_load_dwordx2 s[8:9], s[0:1], 16
    s_mov_b32 s3, s2
    s_and_b32 s56, s2, 7
    s_lshr_b32 s77, s2, 3
    s_lshr_b32 s74, s56, 1
    s_lshl_b32 s74, s74, 2
    s_and_b32 s75, s77, 3
    s_add_u32 s56, s74, s75
    s_and_b32 s74, s2, 1
    s_lshr_b32 s76, s77, 2
    s_lshl_b32 s74, s74, 3
    s_add_u32 s57, s74, s76
    s_lshl_b32 s75, s75, 1
    s_add_u32 s75, s75, s76
    s_cmp_ge_u32 s75, 7
    s_cselect_b32 s76, 7, 0
    s_sub_u32 s75, s75, s76
    s_mul_i32 s76, s56, 114688
    s_mul_i32 s77, s58, 28672
    s_add_u32 s76, s76, s77
    s_lshl_b32 s77, s75, 7
    s_add_u32 s60, s76, s77
    s_mul_i32 s67, s75, 172032
    s_add_u32 s75, s75, 1
    s_cmp_eq_u32 s75, 7
    s_cselect_b32 s75, 0, s75
    s_lshl_b32 s77, s75, 7
    s_add_u32 s61, s76, s77
    s_mul_i32 s68, s75, 172032
    s_add_u32 s75, s75, 1
    s_cmp_eq_u32 s75, 7
    s_cselect_b32 s75, 0, s75
    s_lshl_b32 s77, s75, 7
    s_add_u32 s62, s76, s77
    s_mul_i32 s69, s75, 172032
    s_add_u32 s75, s75, 1
    s_cmp_eq_u32 s75, 7
    s_cselect_b32 s75, 0, s75
    s_lshl_b32 s77, s75, 7
    s_add_u32 s63, s76, s77
    s_mul_i32 s70, s75, 172032
    s_add_u32 s75, s75, 1
    s_cmp_eq_u32 s75, 7
    s_cselect_b32 s75, 0, s75
    s_lshl_b32 s77, s75, 7
    s_add_u32 s64, s76, s77
    s_mul_i32 s71, s75, 172032
    s_add_u32 s75, s75, 1
    s_cmp_eq_u32 s75, 7
    s_cselect_b32 s75, 0, s75
    s_lshl_b32 s77, s75, 7
    s_add_u32 s65, s76, s77
    s_mul_i32 s72, s75, 172032
    s_add_u32 s75, s75, 1
    s_cmp_eq_u32 s75, 7
    s_cselect_b32 s75, 0, s75
    s_lshl_b32 s77, s75, 7
    s_add_u32 s66, s76, s77
    s_mul_i32 s73, s75, 172032
    s_mul_i32 s86, s58, 12288
    v_lshrrev_b32 v11, 3, v0
    v_mul_u32_u24 v11, 896, v11
    v_and_b32 v12, 7, v0
    v_lshrrev_b32 v14, 4, v0
    v_xor_b32 v15, v12, v14
    v_lshl_add_u32 v1, v15, 4, v11
    v_xor_b32 v15, 4, v15
    v_lshl_add_u32 v2, v15, 4, v11
    s_lshl_b32 s87, s58, 10
    v_lshrrev_b32 v11, 2, v0
    s_lshl_b32 s74, s58, 4
    v_add_u32 v11, s74, v11
    v_mul_u32_u24 v11, 2688, v11
    v_and_b32 v12, 3, v0
    v_lshlrev_b32 v14, 4, v12
    v_min_u32_e64 v14, 40, v14
    s_mul_i32 s74, s57, 56
    v_add3_u32 v3, v11, v14, s74
    v_lshlrev_b32_e64 v10, 4, v0
    v_mov_b32 v24, 7340032
    s_waitcnt lgkmcnt(0)
    s_mov_b32 s28, s4
    s_and_b32 s29, s5, 0xffff
    s_mov_b32 s30, 1835008
    s_mov_b32 s31, 0x20000
    s_mov_b32 s32, s6
    s_and_b32 s33, s7, 0xffff
    s_mov_b32 s34, 1204224
    s_mov_b32 s35, 0x20000
    s_mov_b32 s36, s26
    s_and_b32 s37, s27, 0xffff
    s_mov_b32 s38, 268435456
    s_mov_b32 s39, 0x20000
    s_mov_b32 s48, s8
    s_and_b32 s49, s9, 0xffff
    s_mov_b32 s50, 25088
    s_mov_b32 s51, 0x20000
    buffer_load_dword v30, v24, s[36:39], 0 offen sc0 sc1
    s_mul_i32 s74, s57, 1568
    s_lshl_b32 s75, s58, 11
    s_add_u32 s75, s75, 73728
    s_mov_b32 m0, s75
    s_nop 0
    buffer_load_dwordx4 v10, s[48:51], s74 offen lds
    s_add_u32 s74, s74, 1024
    s_add_u32 m0, s75, 1024
    s_nop 0
    buffer_load_dwordx4 v10, s[48:51], s74 offen lds
    s_waitcnt vmcnt(5)
    s_add_u32 s95, s60, 0
    s_add_u32 m0, s86, 0
    s_nop 0
    buffer_load_dwordx4 v1, s[28:31], s95 offen lds
    s_waitcnt vmcnt(5)
    s_add_u32 s95, s60, 7168
    s_add_u32 m0, s86, 1024
    s_nop 0
    buffer_load_dwordx4 v2, s[28:31], s95 offen lds
    s_waitcnt vmcnt(5)
    s_add_u32 s95, s60, 14336
    s_add_u32 m0, s86, 2048
    s_nop 0
    buffer_load_dwordx4 v1, s[28:31], s95 offen lds
    s_waitcnt vmcnt(5)
    s_add_u32 s95, s60, 21504
    s_add_u32 m0, s86, 3072
    s_nop 0
    buffer_load_dwordx4 v2, s[28:31], s95 offen lds
    s_waitcnt vmcnt(5)
    s_add_u32 s95, s67, 896
    s_add_u32 m0, s87, 49152
    s_nop 0
    buffer_load_dwordx4 v3, s[32:35], s95 offen lds
    s_waitcnt vmcnt(5)
    s_add_u32 s95, s67, 1792
    s_add_u32 m0, s87, 53248
    s_nop 0
    buffer_load_dwordx4 v3, s[32:35], s95 offen lds
    s_waitcnt vmcnt(5)
    s_add_u32 s95, s61, 0
    s_add_u32 m0, s86, 4096
    s_nop 0
    buffer_load_dwordx4 v1, s[28:31], s95 offen lds
    v_and_b32 v11, 31, v0
    v_lshrrev_b32 v12, 5, v0
    v_bfe_u32 v14, v0, 1, 3
    v_xor_b32 v12, v12, v14
    v_lshlrev_b32 v11, 7, v11
    v_add_u32 v11, s86, v11
    v_xor_b32_e64 v14, 0, v12
    v_lshl_add_u32 v4, v14, 4, v11
    s_waitcnt vmcnt(5)
    s_add_u32 s95, s61, 7168
    s_add_u32 m0, s86, 5120
    s_nop 0
    buffer_load_dwordx4 v2, s[28:31], s95 offen lds
    v_xor_b32 v14, 2, v12
    v_lshl_add_u32 v5, v14, 4, v11
    v_xor_b32 v14, 4, v12
    v_lshl_add_u32 v6, v14, 4, v11
    v_xor_b32 v14, 6, v12
    v_lshl_add_u32 v7, v14, 4, v11
    v_lshrrev_b32_e64 v11, 5, v0
    v_bfe_u32 v12, v0, 2, 2
    v_lshl_add_u32 v11, v11, 3, v12
    s_waitcnt vmcnt(5)
    s_add_u32 s95, s61, 14336
    s_add_u32 m0, s86, 6144
    s_nop 0
    buffer_load_dwordx4 v1, s[28:31], s95 offen lds
    v_lshlrev_b32_e64 v11, 6, v11
    v_bfe_u32 v12, v0, 4, 1
    v_lshl_add_u32 v11, v12, 5, v11
    v_and_b32_e64 v12, 3, v0
    v_lshl_add_u32 v11, v12, 3, v11
    v_add_u32 v8, 49152, v11
    v_add_u32 v9, 32768, v11
    s_mov_b32 s78, 0x3fb8aa3b
    s_mov_b32 s79, 0x3fb8aa3b
    s_waitcnt vmcnt(5)
    s_add_u32 s95, s61, 21504
    s_add_u32 m0, s86, 7168
    s_nop 0
    buffer_load_dwordx4 v2, s[28:31], s95 offen lds
    s_mov_b32 s93, 0xffff0000
    v_and_b32 v11, 31, v0
    v_cmp_eq_u32 s[82:83], 24, v11
    s_mov_b32 s84, 0
    s_mov_b32 s85, -1
    v_lshrrev_b32 v12, 5, v0
    v_lshlrev_b32 v12, 2, v12
    v_sub_u32 v12, v11, v12
    v_mov_b32 v14, 0x3f80
    s_waitcnt vmcnt(5)
    s_add_u32 s95, s68, 896
    s_add_u32 m0, s87, 57344
    s_nop 0
    buffer_load_dwordx4 v3, s[32:35], s95 offen lds
    v_subrev_u32 v15, 0, v12
    v_lshlrev_b32 v16, 4, v15
    v_cmp_gt_u32 vcc, 2, v15
    v_lshlrev_b32 v16, v16, v14
    s_nop 0
    v_cndmask_b32 v16, 0, v16, vcc
    v_accvgpr_write_b32 a112, v16
    v_subrev_u32 v15, 2, v12
    v_lshlrev_b32_e64 v16, 4, v15
    s_waitcnt vmcnt(5)
    s_add_u32 s95, s68, 1792
    s_add_u32 m0, s87, 61440
    s_nop 0
    buffer_load_dwordx4 v3, s[32:35], s95 offen lds
    v_cmp_gt_u32 vcc, 2, v15
    v_lshlrev_b32 v16, v16, v14
    s_nop 0
    v_cndmask_b32 v16, 0, v16, vcc
    v_accvgpr_write_b32 a113, v16
    v_subrev_u32 v15, 8, v12
    v_lshlrev_b32 v16, 4, v15
    v_cmp_gt_u32 vcc, 2, v15
    v_lshlrev_b32 v16, v16, v14
    s_nop 0
    v_cndmask_b32 v16, 0, v16, vcc
    s_waitcnt vmcnt(5)
    s_add_u32 s95, s62, 0
    s_add_u32 m0, s86, 8192
    s_nop 0
    buffer_load_dwordx4 v1, s[28:31], s95 offen lds
    v_accvgpr_write_b32 a114, v16
    v_subrev_u32 v15, 10, v12
    v_lshlrev_b32 v16, 4, v15
    v_cmp_gt_u32 vcc, 2, v15
    v_lshlrev_b32 v16, v16, v14
    s_nop 0
    v_cndmask_b32 v16, 0, v16, vcc
    v_accvgpr_write_b32 a115, v16
    v_subrev_u32 v15, 16, v12
    v_lshlrev_b32_e64 v16, 4, v15
    s_waitcnt vmcnt(5)
    s_add_u32 s95, s62, 7168
    s_add_u32 m0, s86, 9216
    s_nop 0
    buffer_load_dwordx4 v2, s[28:31], s95 offen lds
    v_cmp_gt_u32 vcc, 2, v15
    v_lshlrev_b32 v16, v16, v14
    s_nop 0
    v_cndmask_b32 v16, 0, v16, vcc
    v_accvgpr_write_b32 a116, v16
    v_subrev_u32 v15, 18, v12
    v_lshlrev_b32 v16, 4, v15
    v_cmp_gt_u32 vcc, 2, v15
    v_lshlrev_b32_e64 v16, v16, v14
    s_nop 0
    v_cndmask_b32 v16, 0, v16, vcc
    s_waitcnt vmcnt(5)
    s_add_u32 s95, s62, 14336
    s_add_u32 m0, s86, 10240
    s_nop 0
    buffer_load_dwordx4 v1, s[28:31], s95 offen lds
    v_accvgpr_write_b32 a117, v16
    v_subrev_u32 v15, 24, v12
    v_lshlrev_b32 v16, 4, v15
    v_cmp_gt_u32 vcc, 2, v15
    v_lshlrev_b32 v16, v16, v14
    s_nop 0
    v_cndmask_b32 v16, 0, v16, vcc
    v_accvgpr_write_b32 a118, v16
    v_subrev_u32 v15, 26, v12
    s_waitcnt vmcnt(5)
    s_add_u32 s95, s62, 21504
    s_add_u32 m0, s86, 11264
    s_nop 0
    buffer_load_dwordx4 v2, s[28:31], s95 offen lds
    v_lshlrev_b32 v16, 4, v15
    v_cmp_gt_u32 vcc, 2, v15
    v_lshlrev_b32 v16, v16, v14
    s_nop 0
    v_cndmask_b32 v16, 0, v16, vcc
    v_accvgpr_write_b32 a119, v16
    v_and_b32 v11, 3, v0
    v_lshlrev_b32 v11, 2, v11
    v_bfe_u32 v12, v0, 4, 1
    v_lshl_add_u32 v11, v12, 4, v11
    s_waitcnt vmcnt(5)
    s_add_u32 s95, s69, 896
    s_add_u32 m0, s87, 65536
    s_nop 0
    buffer_load_dwordx4 v3, s[32:35], s95 offen lds
    v_min_u32 v11, 24, v11
    v_lshrrev_b32 v12, 5, v0
    v_bfe_u32 v14, v0, 2, 2
    v_lshl_add_u32 v12, v12, 2, v14
    v_mul_u32_u24 v12, 56, v12
    v_lshl_add_u32 v11, v11, 1, v12
    s_lshl_b32 s74, s58, 11
    s_add_u32 s74, s74, 73728
    v_add_u32_e64 v11, s74, v11
    s_waitcnt vmcnt(5)
    s_add_u32 s95, s69, 1792
    s_add_u32 m0, s87, 69632
    s_nop 0
    buffer_load_dwordx4 v3, s[32:35], s95 offen lds
    ds_read_b64_tr_b16 a[120:121], v11
    ds_read_b64_tr_b16 a[122:123], v11 offset:448
    ds_read_b64_tr_b16 a[124:125], v11 offset:896
    ds_read_b64_tr_b16 v[22:23], v11 offset:1120
    s_waitcnt lgkmcnt(0)
    v_cndmask_b32 v22, 0, v22, s[84:85]
    v_cndmask_b32 v23, 0, v23, s[84:85]
    v_accvgpr_write_b32 a126, v22
    v_accvgpr_write_b32 a127, v23
    v_add_u32 v30, 1, v30
    s_nop 0
    v_readfirstlane_b32 s80, v30
    ds_read_b128 a[0:3], v4 offset:0
    ds_read_b128 a[4:7], v5 offset:0
    ds_read_b128 a[8:11], v6 offset:0
    ds_read_b128 a[12:15], v7 offset:0
    s_waitcnt lgkmcnt(0)
    s_barrier
    ds_read_b64_tr_b16 v[64:65], v8 offset:0
    ds_read_b64_tr_b16 v[66:67], v8 offset:256
    ds_read_b64_tr_b16 v[68:69], v8 offset:4096
    ds_read_b64_tr_b16 v[70:71], v8 offset:4352
    ds_read_b64_tr_b16 v[72:73], v8 offset:1024
    ds_read_b64_tr_b16 v[74:75], v8 offset:1280
    ds_read_b64_tr_b16 v[76:77], v8 offset:5120
    ds_read_b64_tr_b16 v[78:79], v8 offset:5376
    ds_read_b64_tr_b16 v[80:81], v8 offset:2048
    ds_read_b64_tr_b16 v[82:83], v8 offset:2304
    ds_read_b64_tr_b16 v[84:85], v8 offset:6144
    ds_read_b64_tr_b16 v[86:87], v8 offset:6400
    s_waitcnt vmcnt(5)
    s_add_u32 s95, s63, 0
    s_add_u32 m0, s86, 0
    s_nop 0
    buffer_load_dwordx4 v1, s[28:31], s95 offen lds
    ds_read_b64_tr_b16 v[88:89], v8 offset:3072
    ds_read_b64_tr_b16 v[90:91], v8 offset:3328
    s_waitcnt vmcnt(5)
    s_add_u32 s95, s63, 7168
    s_add_u32 m0, s86, 1024
    s_nop 0
    buffer_load_dwordx4 v2, s[28:31], s95 offen lds
    ds_read_b64_tr_b16 v[92:93], v8 offset:7168
    ds_read_b64_tr_b16 v[94:95], v8 offset:7424
    s_waitcnt vmcnt(5)
    s_add_u32 s95, s63, 14336
    s_add_u32 m0, s86, 2048
    s_nop 0
    buffer_load_dwordx4 v1, s[28:31], s95 offen lds
    s_waitcnt lgkmcnt(14)
    v_mfma_f32_32x32x16_bf16 v[32:47], v[64:67], a[0:3], 0
    s_waitcnt lgkmcnt(12)
    v_mfma_f32_32x32x16_bf16 v[48:63], a[0:3], v[68:71], 0
    s_waitcnt vmcnt(5)
    s_add_u32 s95, s63, 21504
    s_add_u32 m0, s86, 3072
    s_nop 0
    buffer_load_dwordx4 v2, s[28:31], s95 offen lds
    s_waitcnt lgkmcnt(10)
    v_mfma_f32_32x32x16_bf16 v[32:47], v[72:75], a[4:7], v[32:47]
    s_waitcnt lgkmcnt(8)
    v_mfma_f32_32x32x16_bf16 v[48:63], a[4:7], v[76:79], v[48:63]
    s_waitcnt vmcnt(5)
    s_add_u32 s95, s70, 896
    s_add_u32 m0, s87, 73728
    s_nop 0
    buffer_load_dwordx4 v3, s[32:35], s95 offen lds
    s_waitcnt lgkmcnt(6)
    v_mfma_f32_32x32x16_bf16 v[32:47], v[80:83], a[8:11], v[32:47]
    s_waitcnt lgkmcnt(4)
    v_mfma_f32_32x32x16_bf16 v[48:63], a[8:11], v[84:87], v[48:63]
    s_waitcnt vmcnt(5)
    s_add_u32 s95, s70, 1792
    s_add_u32 m0, s87, 77824
    s_nop 0
    buffer_load_dwordx4 v3, s[32:35], s95 offen lds
    s_waitcnt lgkmcnt(2)
    v_mfma_f32_32x32x16_bf16 v[32:47], v[88:91], a[12:15], v[32:47]
    s_waitcnt lgkmcnt(0)
    v_mfma_f32_32x32x16_bf16 v[48:63], a[12:15], v[92:95], v[48:63]
    ds_read_b128 a[16:19], v4 offset:4096
    ds_read_b128 a[20:23], v5 offset:4096
    ds_read_b128 a[24:27], v6 offset:4096
    ds_read_b128 a[28:31], v7 offset:4096
    s_waitcnt lgkmcnt(0)
    s_barrier
    ds_read_b64_tr_b16 v[64:65], v8 offset:8192
    ds_read_b64_tr_b16 v[66:67], v8 offset:8448
    ds_read_b64_tr_b16 v[68:69], v8 offset:12288
    ds_read_b64_tr_b16 v[70:71], v8 offset:12544
    ds_read_b64_tr_b16 v[72:73], v8 offset:9216
    ds_read_b64_tr_b16 v[74:75], v8 offset:9472
    ds_read_b64_tr_b16 v[76:77], v8 offset:13312
    ds_read_b64_tr_b16 v[78:79], v8 offset:13568
    ds_read_b64_tr_b16 v[80:81], v8 offset:10240
    ds_read_b64_tr_b16 v[82:83], v8 offset:10496
    ds_read_b64_tr_b16 v[84:85], v8 offset:14336
    ds_read_b64_tr_b16 v[86:87], v8 offset:14592
    s_waitcnt vmcnt(5)
    s_add_u32 s95, s64, 0
    s_add_u32 m0, s86, 4096
    s_nop 0
    buffer_load_dwordx4 v1, s[28:31], s95 offen lds
    ds_read_b64_tr_b16 v[88:89], v8 offset:11264
    ds_read_b64_tr_b16 v[90:91], v8 offset:11520
    s_waitcnt vmcnt(5)
    s_add_u32 s95, s64, 7168
    s_add_u32 m0, s86, 5120
    s_nop 0
    buffer_load_dwordx4 v2, s[28:31], s95 offen lds
    ds_read_b64_tr_b16 v[92:93], v8 offset:15360
    ds_read_b64_tr_b16 v[94:95], v8 offset:15616
    s_waitcnt vmcnt(5)
    s_add_u32 s95, s64, 14336
    s_add_u32 m0, s86, 6144
    s_nop 0
    buffer_load_dwordx4 v1, s[28:31], s95 offen lds
    s_waitcnt lgkmcnt(14)
    v_mfma_f32_32x32x16_bf16 v[32:47], v[64:67], a[16:19], v[32:47]
    s_waitcnt lgkmcnt(12)
    v_mfma_f32_32x32x16_bf16 v[48:63], a[16:19], v[68:71], v[48:63]
    s_waitcnt vmcnt(5)
    s_add_u32 s95, s64, 21504
    s_add_u32 m0, s86, 7168
    s_nop 0
    buffer_load_dwordx4 v2, s[28:31], s95 offen lds
    s_waitcnt lgkmcnt(10)
    v_mfma_f32_32x32x16_bf16 v[32:47], v[72:75], a[20:23], v[32:47]
    s_waitcnt lgkmcnt(8)
    v_mfma_f32_32x32x16_bf16 v[48:63], a[20:23], v[76:79], v[48:63]
    s_waitcnt vmcnt(5)
    s_add_u32 s95, s71, 896
    s_add_u32 m0, s87, 49152
    s_nop 0
    buffer_load_dwordx4 v3, s[32:35], s95 offen lds
    s_waitcnt lgkmcnt(6)
    v_mfma_f32_32x32x16_bf16 v[32:47], v[80:83], a[24:27], v[32:47]
    s_waitcnt lgkmcnt(4)
    v_mfma_f32_32x32x16_bf16 v[48:63], a[24:27], v[84:87], v[48:63]
    s_waitcnt vmcnt(5)
    s_add_u32 s95, s71, 1792
    s_add_u32 m0, s87, 53248
    s_nop 0
    buffer_load_dwordx4 v3, s[32:35], s95 offen lds
    s_waitcnt lgkmcnt(2)
    v_mfma_f32_32x32x16_bf16 v[32:47], v[88:91], a[28:31], v[32:47]
    s_waitcnt lgkmcnt(0)
    v_mfma_f32_32x32x16_bf16 v[48:63], a[28:31], v[92:95], v[48:63]
    ds_read_b128 a[32:35], v4 offset:8192
    ds_read_b128 a[36:39], v5 offset:8192
    ds_read_b128 a[40:43], v6 offset:8192
    ds_read_b128 a[44:47], v7 offset:8192
    s_waitcnt lgkmcnt(0)
    s_barrier
    s_nop 0
    ds_read_b64_tr_b16 v[64:65], v8 offset:16384
    ds_read_b64_tr_b16 v[66:67], v8 offset:16640
    ds_read_b64_tr_b16 v[68:69], v8 offset:20480
    ds_read_b64_tr_b16 v[70:71], v8 offset:20736
    ds_read_b64_tr_b16 v[72:73], v8 offset:17408
    ds_read_b64_tr_b16 v[74:75], v8 offset:17664
    ds_read_b64_tr_b16 v[76:77], v8 offset:21504
    ds_read_b64_tr_b16 v[78:79], v8 offset:21760
    ds_read_b64_tr_b16 v[80:81], v8 offset:18432
    ds_read_b64_tr_b16 v[82:83], v8 offset:18688
    ds_read_b64_tr_b16 v[84:85], v8 offset:22528
    ds_read_b64_tr_b16 v[86:87], v8 offset:22784
    s_waitcnt vmcnt(5)
    s_add_u32 s95, s65, 0
    s_add_u32 m0, s86, 8192
    s_nop 0
    buffer_load_dwordx4 v1, s[28:31], s95 offen lds
    ds_read_b64_tr_b16 v[88:89], v8 offset:19456
    ds_read_b64_tr_b16 v[90:91], v8 offset:19712
    s_waitcnt vmcnt(5)
    s_add_u32 s95, s65, 7168
    s_add_u32 m0, s86, 9216
    s_nop 0
    buffer_load_dwordx4 v2, s[28:31], s95 offen lds
    ds_read_b64_tr_b16 v[92:93], v8 offset:23552
    ds_read_b64_tr_b16 v[94:95], v8 offset:23808
    s_waitcnt vmcnt(5)
    s_add_u32 s95, s65, 14336
    s_add_u32 m0, s86, 10240
    s_nop 0
    buffer_load_dwordx4 v1, s[28:31], s95 offen lds
    s_waitcnt lgkmcnt(14)
    v_mfma_f32_32x32x16_bf16 v[32:47], v[64:67], a[32:35], v[32:47]
    s_waitcnt lgkmcnt(12)
    v_mfma_f32_32x32x16_bf16 v[48:63], a[32:35], v[68:71], v[48:63]
    s_waitcnt vmcnt(5)
    s_add_u32 s95, s65, 21504
    s_add_u32 m0, s86, 11264
    s_nop 0
    buffer_load_dwordx4 v2, s[28:31], s95 offen lds
    s_waitcnt lgkmcnt(10)
    v_mfma_f32_32x32x16_bf16 v[32:47], v[72:75], a[36:39], v[32:47]
    s_waitcnt lgkmcnt(8)
    v_mfma_f32_32x32x16_bf16 v[48:63], a[36:39], v[76:79], v[48:63]
    s_waitcnt vmcnt(5)
    s_add_u32 s95, s72, 896
    s_add_u32 m0, s87, 57344
    s_nop 0
    buffer_load_dwordx4 v3, s[32:35], s95 offen lds
    s_waitcnt lgkmcnt(6)
    v_mfma_f32_32x32x16_bf16 v[32:47], v[80:83], a[40:43], v[32:47]
    s_waitcnt lgkmcnt(4)
    v_mfma_f32_32x32x16_bf16 v[48:63], a[40:43], v[84:87], v[48:63]
    s_waitcnt vmcnt(5)
    s_add_u32 s95, s72, 1792
    s_add_u32 m0, s87, 61440
    s_nop 0
    buffer_load_dwordx4 v3, s[32:35], s95 offen lds
    s_waitcnt lgkmcnt(2)
    v_mfma_f32_32x32x16_bf16 v[32:47], v[88:91], a[44:47], v[32:47]
    s_waitcnt lgkmcnt(0)
    v_mfma_f32_32x32x16_bf16 v[48:63], a[44:47], v[92:95], v[48:63]
    ds_read_b128 a[48:51], v4 offset:0
    ds_read_b128 a[52:55], v5 offset:0
    ds_read_b128 a[56:59], v6 offset:0
    ds_read_b128 a[60:63], v7 offset:0
    s_waitcnt lgkmcnt(0)
    s_barrier
    ds_read_b64_tr_b16 v[64:65], v8 offset:24576
    ds_read_b64_tr_b16 v[66:67], v8 offset:24832
    ds_read_b64_tr_b16 v[68:69], v8 offset:28672
    s_nop 0
    ds_read_b64_tr_b16 v[70:71], v8 offset:28928
    ds_read_b64_tr_b16 v[72:73], v8 offset:25600
    ds_read_b64_tr_b16 v[74:75], v8 offset:25856
    ds_read_b64_tr_b16 v[76:77], v8 offset:29696
    ds_read_b64_tr_b16 v[78:79], v8 offset:29952
    ds_read_b64_tr_b16 v[80:81], v8 offset:26624
    ds_read_b64_tr_b16 v[82:83], v8 offset:26880
    ds_read_b64_tr_b16 v[84:85], v8 offset:30720
    ds_read_b64_tr_b16 v[86:87], v8 offset:30976
    s_waitcnt vmcnt(5)
    s_add_u32 s95, s66, 0
    s_add_u32 m0, s86, 0
    s_nop 0
    buffer_load_dwordx4 v1, s[28:31], s95 offen lds
    ds_read_b64_tr_b16 v[88:89], v8 offset:27648
    ds_read_b64_tr_b16 v[90:91], v8 offset:27904
    s_waitcnt vmcnt(5)
    s_add_u32 s95, s66, 7168
    s_add_u32 m0, s86, 1024
    s_nop 0
    buffer_load_dwordx4 v2, s[28:31], s95 offen lds
    ds_read_b64_tr_b16 v[92:93], v8 offset:31744
    ds_read_b64_tr_b16 v[94:95], v8 offset:32000
    s_waitcnt vmcnt(5)
    s_add_u32 s95, s66, 14336
    s_add_u32 m0, s86, 2048
    s_nop 0
    buffer_load_dwordx4 v1, s[28:31], s95 offen lds
    s_waitcnt lgkmcnt(14)
    v_mfma_f32_32x32x16_bf16 v[32:47], v[64:67], a[48:51], v[32:47]
    s_waitcnt lgkmcnt(12)
    v_mfma_f32_32x32x16_bf16 v[48:63], a[48:51], v[68:71], v[48:63]
    s_waitcnt vmcnt(5)
    s_add_u32 s95, s66, 21504
    s_add_u32 m0, s86, 3072
    s_nop 0
    buffer_load_dwordx4 v2, s[28:31], s95 offen lds
    s_waitcnt lgkmcnt(10)
    v_mfma_f32_32x32x16_bf16 v[32:47], v[72:75], a[52:55], v[32:47]
    s_waitcnt lgkmcnt(8)
    v_mfma_f32_32x32x16_bf16 v[48:63], a[52:55], v[76:79], v[48:63]
    s_waitcnt vmcnt(5)
    s_add_u32 s95, s73, 896
    s_add_u32 m0, s87, 65536
    s_nop 0
    buffer_load_dwordx4 v3, s[32:35], s95 offen lds
    s_waitcnt lgkmcnt(6)
    v_mfma_f32_32x32x16_bf16 v[32:47], v[80:83], a[56:59], v[32:47]
    s_waitcnt lgkmcnt(4)
    v_mfma_f32_32x32x16_bf16 v[48:63], a[56:59], v[84:87], v[48:63]
    s_waitcnt vmcnt(5)
    s_add_u32 s95, s73, 1792
    s_add_u32 m0, s87, 69632
    s_nop 0
    buffer_load_dwordx4 v3, s[32:35], s95 offen lds
    s_waitcnt lgkmcnt(2)
    v_mfma_f32_32x32x16_bf16 v[32:47], v[88:91], a[60:63], v[32:47]
    s_waitcnt lgkmcnt(0)
    v_mfma_f32_32x32x16_bf16 v[48:63], a[60:63], v[92:95], v[48:63]
    ds_read_b128 a[64:67], v4 offset:4096
    ds_read_b128 a[68:71], v5 offset:4096
    ds_read_b128 a[72:75], v6 offset:4096
    ds_read_b128 a[76:79], v7 offset:4096
    s_waitcnt lgkmcnt(0)
    s_barrier
    ds_read_b64_tr_b16 v[64:65], v8 offset:0
    ds_read_b64_tr_b16 v[66:67], v8 offset:256
    ds_read_b64_tr_b16 v[68:69], v8 offset:4096
    ds_read_b64_tr_b16 v[70:71], v8 offset:4352
    ds_read_b64_tr_b16 v[72:73], v8 offset:1024
    ds_read_b64_tr_b16 v[74:75], v8 offset:1280
    ds_read_b64_tr_b16 v[76:77], v8 offset:5120
    ds_read_b64_tr_b16 v[78:79], v8 offset:5376
    ds_read_b64_tr_b16 v[80:81], v8 offset:2048
    ds_read_b64_tr_b16 v[82:83], v8 offset:2304
    ds_read_b64_tr_b16 v[84:85], v8 offset:6144
    ds_read_b64_tr_b16 v[86:87], v8 offset:6400
    ds_read_b64_tr_b16 v[88:89], v8 offset:3072
    ds_read_b64_tr_b16 v[90:91], v8 offset:3328
    ds_read_b64_tr_b16 v[92:93], v8 offset:7168
    ds_read_b64_tr_b16 v[94:95], v8 offset:7424
    s_waitcnt lgkmcnt(14)
    v_mfma_f32_32x32x16_bf16 v[32:47], v[64:67], a[64:67], v[32:47]
    s_waitcnt lgkmcnt(12)
    v_mfma_f32_32x32x16_bf16 v[48:63], a[64:67], v[68:71], v[48:63]
    s_waitcnt lgkmcnt(10)
    v_mfma_f32_32x32x16_bf16 v[32:47], v[72:75], a[68:71], v[32:47]
    s_waitcnt lgkmcnt(8)
    v_mfma_f32_32x32x16_bf16 v[48:63], a[68:71], v[76:79], v[48:63]
    s_waitcnt lgkmcnt(6)
    v_mfma_f32_32x32x16_bf16 v[32:47], v[80:83], a[72:75], v[32:47]
    s_waitcnt lgkmcnt(4)
    v_mfma_f32_32x32x16_bf16 v[48:63], a[72:75], v[84:87], v[48:63]
    s_waitcnt lgkmcnt(2)
    v_mfma_f32_32x32x16_bf16 v[32:47], v[88:91], a[76:79], v[32:47]
    s_waitcnt lgkmcnt(0)
    v_mfma_f32_32x32x16_bf16 v[48:63], a[76:79], v[92:95], v[48:63]
    ds_read_b128 a[80:83], v4 offset:8192
    ds_read_b128 a[84:87], v5 offset:8192
    ds_read_b128 a[88:91], v6 offset:8192
    ds_read_b128 a[92:95], v7 offset:8192
    s_waitcnt lgkmcnt(0)
    s_barrier
    ds_read_b64_tr_b16 v[64:65], v8 offset:8192
    ds_read_b64_tr_b16 v[66:67], v8 offset:8448
    ds_read_b64_tr_b16 v[68:69], v8 offset:12288
    ds_read_b64_tr_b16 v[70:71], v8 offset:12544
    ds_read_b64_tr_b16 v[72:73], v8 offset:9216
    ds_read_b64_tr_b16 v[74:75], v8 offset:9472
    ds_read_b64_tr_b16 v[76:77], v8 offset:13312
    ds_read_b64_tr_b16 v[78:79], v8 offset:13568
    ds_read_b64_tr_b16 v[80:81], v8 offset:10240
    ds_read_b64_tr_b16 v[82:83], v8 offset:10496
    ds_read_b64_tr_b16 v[84:85], v8 offset:14336
    ds_read_b64_tr_b16 v[86:87], v8 offset:14592
    ds_read_b64_tr_b16 v[88:89], v8 offset:11264
    ds_read_b64_tr_b16 v[90:91], v8 offset:11520
    ds_read_b64_tr_b16 v[92:93], v8 offset:15360
    ds_read_b64_tr_b16 v[94:95], v8 offset:15616
    s_waitcnt lgkmcnt(14)
    v_mfma_f32_32x32x16_bf16 v[32:47], v[64:67], a[80:83], v[32:47]
    s_waitcnt lgkmcnt(12)
    v_mfma_f32_32x32x16_bf16 v[48:63], a[80:83], v[68:71], v[48:63]
    s_waitcnt lgkmcnt(10)
    v_mfma_f32_32x32x16_bf16 v[32:47], v[72:75], a[84:87], v[32:47]
    s_waitcnt lgkmcnt(8)
    v_mfma_f32_32x32x16_bf16 v[48:63], a[84:87], v[76:79], v[48:63]
    s_waitcnt lgkmcnt(6)
    v_mfma_f32_32x32x16_bf16 v[32:47], v[80:83], a[88:91], v[32:47]
    s_waitcnt lgkmcnt(4)
    v_mfma_f32_32x32x16_bf16 v[48:63], a[88:91], v[84:87], v[48:63]
    s_waitcnt lgkmcnt(2)
    v_mfma_f32_32x32x16_bf16 v[32:47], v[88:91], a[92:95], v[32:47]
    s_waitcnt lgkmcnt(0)
    v_mfma_f32_32x32x16_bf16 v[48:63], a[92:95], v[92:95], v[48:63]
    s_waitcnt vmcnt(0)
    ds_read_b128 a[96:99], v4 offset:0
    ds_read_b128 a[100:103], v5 offset:0
    ds_read_b128 a[104:107], v6 offset:0
    ds_read_b128 a[108:111], v7 offset:0
    s_waitcnt lgkmcnt(0)
    s_barrier
    s_nop 0
    ds_read_b64_tr_b16 v[64:65], v8 offset:16384
    ds_read_b64_tr_b16 v[66:67], v8 offset:16640
    ds_read_b64_tr_b16 v[68:69], v8 offset:20480
    ds_read_b64_tr_b16 v[70:71], v8 offset:20736
    ds_read_b64_tr_b16 v[72:73], v8 offset:17408
    ds_read_b64_tr_b16 v[74:75], v8 offset:17664
    ds_read_b64_tr_b16 v[76:77], v8 offset:21504
    ds_read_b64_tr_b16 v[78:79], v8 offset:21760
    ds_read_b64_tr_b16 v[80:81], v8 offset:18432
    ds_read_b64_tr_b16 v[82:83], v8 offset:18688
    ds_read_b64_tr_b16 v[84:85], v8 offset:22528
    ds_read_b64_tr_b16 v[86:87], v8 offset:22784
    s_add_u32 s95, s67, 0
    s_add_u32 m0, s87, 73728
    s_nop 0
    buffer_load_dwordx4 v3, s[32:35], s95 offen lds
    ds_read_b64_tr_b16 v[88:89], v8 offset:19456
    ds_read_b64_tr_b16 v[90:91], v8 offset:19712
    s_add_u32 s95, s68, 0
    s_add_u32 m0, s87, 77824
    s_nop 0
    buffer_load_dwordx4 v3, s[32:35], s95 offen lds
    ds_read_b64_tr_b16 v[92:93], v8 offset:23552
    ds_read_b64_tr_b16 v[94:95], v8 offset:23808
    s_add_u32 s95, s69, 0
    s_add_u32 m0, s87, 49152
    s_nop 0
    buffer_load_dwordx4 v3, s[32:35], s95 offen lds
    s_waitcnt lgkmcnt(14)
    v_mfma_f32_32x32x16_bf16 v[32:47], v[64:67], a[96:99], v[32:47]
    s_waitcnt lgkmcnt(12)
    v_mfma_f32_32x32x16_bf16 v[48:63], a[96:99], v[68:71], v[48:63]
    s_add_u32 s95, s70, 0
    s_add_u32 m0, s87, 53248
    s_nop 0
    buffer_load_dwordx4 v3, s[32:35], s95 offen lds
    s_waitcnt lgkmcnt(10)
    v_mfma_f32_32x32x16_bf16 v[32:47], v[72:75], a[100:103], v[32:47]
    s_waitcnt lgkmcnt(8)
    v_mfma_f32_32x32x16_bf16 v[48:63], a[100:103], v[76:79], v[48:63]
    s_add_u32 s95, s71, 0
    s_add_u32 m0, s87, 57344
    s_nop 0
    buffer_load_dwordx4 v3, s[32:35], s95 offen lds
    s_waitcnt lgkmcnt(6)
    v_mfma_f32_32x32x16_bf16 v[32:47], v[80:83], a[104:107], v[32:47]
    s_waitcnt lgkmcnt(4)
    v_mfma_f32_32x32x16_bf16 v[48:63], a[104:107], v[84:87], v[48:63]
    s_add_u32 s95, s72, 0
    s_add_u32 m0, s87, 61440
    s_nop 0
    buffer_load_dwordx4 v3, s[32:35], s95 offen lds
    s_waitcnt lgkmcnt(2)
    v_mfma_f32_32x32x16_bf16 v[32:47], v[88:91], a[108:111], v[32:47]
    s_waitcnt lgkmcnt(0)
    v_mfma_f32_32x32x16_bf16 v[48:63], a[108:111], v[92:95], v[48:63]
    s_setprio 2
    s_nop 8
    v_cvt_pk_bf16_f32 v64, v32, v33
    v_cvt_pk_bf16_f32 v65, v34, v35
    v_cvt_pk_bf16_f32 v66, v36, v37
    v_cvt_pk_bf16_f32 v67, v38, v39
    v_cvt_pk_bf16_f32 v68, v40, v41
    v_cvt_pk_bf16_f32 v69, v42, v43
    v_cvt_pk_bf16_f32 v70, v44, v45
    v_cvt_pk_bf16_f32 v71, v46, v47
    v_mfma_f32_32x32x16_bf16 v[72:87], a[120:123], v[64:67], 0
    s_nop 0
    v_mfma_f32_32x32x16_bf16 v[72:87], a[124:127], v[68:71], v[72:87]
    v_cvt_pk_bf16_f32 v88, v48, v49
    v_cvt_pk_bf16_f32 v89, v50, v51
    s_nop 0
    v_cvt_pk_bf16_f32 v90, v52, v53
    v_cvt_pk_bf16_f32 v91, v54, v55
    v_cvt_pk_bf16_f32 v92, v56, v57
    v_cvt_pk_bf16_f32 v93, v58, v59
    v_cvt_pk_bf16_f32 v94, v60, v61
    v_cvt_pk_bf16_f32 v95, v62, v63
    v_mov_b32 v24, 0x3f803f80
    v_cndmask_b32 v88, v88, v24, s[82:83]
    v_cndmask_b32 v89, v89, v24, s[82:83]
    v_cndmask_b32 v90, v90, v24, s[82:83]
    v_cndmask_b32 v91, v91, v24, s[82:83]
    v_cndmask_b32 v92, v92, v24, s[82:83]
    v_cndmask_b32 v93, v93, v24, s[82:83]
    v_cndmask_b32 v94, v94, v24, s[82:83]
    v_cndmask_b32 v95, v95, v24, s[82:83]
    v_max3_f32 v12, v72, v73, v74
    v_min3_f32 v14, v72, v73, v74
    v_max3_f32 v12, v12, v75, v76
    v_min3_f32 v14, v14, v75, v76
    v_max3_f32 v12, v12, v77, v78
    v_min3_f32 v14, v14, v77, v78
    v_max3_f32 v12, v12, v79, v80
    v_min3_f32 v14, v14, v79, v80
    v_max3_f32 v12, v12, v81, v82
    v_min3_f32 v14, v14, v81, v82
    v_max3_f32 v12, v12, v83, v84
    v_min3_f32 v14, v14, v83, v84
    v_max3_f32 v12, v12, v85, v86
    v_min3_f32 v14, v14, v85, v86
    v_max_f32 v12, v12, v87
    v_min_f32 v14, v14, v87
    v_mov_b32 v16, v12
    v_mov_b32 v18, v14
    s_nop 0
    v_permlane32_swap_b32 v12, v16
    v_permlane32_swap_b32 v14, v18
    v_max_f32 v12, v12, v16
    v_min_f32 v14, v14, v18
    v_mul_f32 v12, s78, v12
    v_mul_f32_e64 v14, s78, v14
    v_pk_fma_f32 v[32:33], v[72:73], s[78:79], v[12:13] op_sel_hi:[1,1,0] neg_lo:[0,0,1] neg_hi:[0,0,1]
    v_pk_fma_f32 v[48:49], v[72:73], s[78:79], v[14:15] op_sel_hi:[1,1,0] neg_lo:[1,0,0] neg_hi:[1,0,0]
    v_pk_fma_f32 v[34:35], v[74:75], s[78:79], v[12:13] op_sel_hi:[1,1,0] neg_lo:[0,0,1] neg_hi:[0,0,1]
    v_pk_fma_f32 v[50:51], v[74:75], s[78:79], v[14:15] op_sel_hi:[1,1,0] neg_lo:[1,0,0] neg_hi:[1,0,0]
    v_pk_fma_f32 v[36:37], v[76:77], s[78:79], v[12:13] op_sel_hi:[1,1,0] neg_lo:[0,0,1] neg_hi:[0,0,1]
    v_pk_fma_f32 v[52:53], v[76:77], s[78:79], v[14:15] op_sel_hi:[1,1,0] neg_lo:[1,0,0] neg_hi:[1,0,0]
    v_pk_fma_f32 v[38:39], v[78:79], s[78:79], v[12:13] op_sel_hi:[1,1,0] neg_lo:[0,0,1] neg_hi:[0,0,1]
    v_pk_fma_f32 v[54:55], v[78:79], s[78:79], v[14:15] op_sel_hi:[1,1,0] neg_lo:[1,0,0] neg_hi:[1,0,0]
    v_pk_fma_f32 v[40:41], v[80:81], s[78:79], v[12:13] op_sel_hi:[1,1,0] neg_lo:[0,0,1] neg_hi:[0,0,1]
    v_pk_fma_f32 v[56:57], v[80:81], s[78:79], v[14:15] op_sel_hi:[1,1,0] neg_lo:[1,0,0] neg_hi:[1,0,0]
    v_pk_fma_f32 v[42:43], v[82:83], s[78:79], v[12:13] op_sel_hi:[1,1,0] neg_lo:[0,0,1] neg_hi:[0,0,1]
    v_pk_fma_f32 v[58:59], v[82:83], s[78:79], v[14:15] op_sel_hi:[1,1,0] neg_lo:[1,0,0] neg_hi:[1,0,0]
    v_pk_fma_f32 v[44:45], v[84:85], s[78:79], v[12:13] op_sel_hi:[1,1,0] neg_lo:[0,0,1] neg_hi:[0,0,1]
    v_pk_fma_f32 v[60:61], v[84:85], s[78:79], v[14:15] op_sel_hi:[1,1,0] neg_lo:[1,0,0] neg_hi:[1,0,0]
    v_pk_fma_f32 v[46:47], v[86:87], s[78:79], v[12:13] op_sel_hi:[1,1,0] neg_lo:[0,0,1] neg_hi:[0,0,1]
    v_pk_fma_f32 v[62:63], v[86:87], s[78:79], v[14:15] op_sel_hi:[1,1,0] neg_lo:[1,0,0] neg_hi:[1,0,0]
    v_exp_f32 v32, v32
    v_exp_f32 v48, v48
    v_exp_f32 v33, v33
    v_exp_f32 v49, v49
    v_exp_f32 v34, v34
    v_exp_f32 v50, v50
    v_exp_f32 v35, v35
    v_exp_f32 v51, v51
    v_exp_f32 v36, v36
    v_exp_f32 v52, v52
    v_exp_f32 v37, v37
    v_exp_f32 v53, v53
    v_exp_f32 v38, v38
    v_exp_f32 v54, v54
    v_exp_f32 v39, v39
    v_exp_f32 v55, v55
    v_exp_f32 v40, v40
    v_exp_f32 v56, v56
    v_exp_f32 v41, v41
    v_exp_f32 v57, v57
    v_exp_f32 v42, v42
    v_exp_f32 v58, v58
    v_exp_f32 v43, v43
    v_exp_f32 v59, v59
    v_exp_f32 v44, v44
    v_exp_f32 v60, v60
    v_exp_f32 v45, v45
    v_exp_f32 v61, v61
    v_exp_f32 v46, v46
    v_exp_f32 v62, v62
    v_exp_f32 v47, v47
    v_exp_f32 v63, v63
    v_cndmask_b32 v44, v44, 0, s[84:85]
    v_cndmask_b32 v60, v60, 0, s[84:85]
    v_cndmask_b32 v45, v45, 0, s[84:85]
    v_cndmask_b32 v61, v61, 0, s[84:85]
    v_cndmask_b32 v46, v46, 0, s[84:85]
    v_cndmask_b32 v62, v62, 0, s[84:85]
    v_cndmask_b32 v47, v47, 0, s[84:85]
    v_cndmask_b32 v63, v63, 0, s[84:85]
    v_pk_add_f32 v[20:21], v[32:33], v[34:35]
    v_pk_add_f32 v[22:23], v[48:49], v[50:51]
    v_pk_add_f32 v[20:21], v[20:21], v[36:37]
    v_pk_add_f32 v[22:23], v[22:23], v[52:53]
    v_pk_add_f32 v[20:21], v[20:21], v[38:39]
    v_pk_add_f32 v[22:23], v[22:23], v[54:55]
    v_pk_add_f32 v[20:21], v[20:21], v[40:41]
    v_pk_add_f32 v[22:23], v[22:23], v[56:57]
    v_pk_add_f32 v[20:21], v[20:21], v[42:43]
    v_pk_add_f32 v[22:23], v[22:23], v[58:59]
    v_pk_add_f32 v[20:21], v[20:21], v[44:45]
    v_pk_add_f32 v[22:23], v[22:23], v[60:61]
    v_pk_add_f32 v[20:21], v[20:21], v[46:47]
    v_pk_add_f32 v[22:23], v[22:23], v[62:63]
    v_add_f32 v20, v20, v21
    v_add_f32 v22, v22, v23
    v_mov_b32 v16, v20
    v_mov_b32 v18, v22
    s_nop 0
    v_permlane32_swap_b32 v20, v16
    v_permlane32_swap_b32 v22, v18
    v_add_f32 v20, v20, v16
    v_add_f32 v22, v22, v18
    v_rcp_f32 v20, v20
    v_rcp_f32_e64 v22, v22
    v_pk_mul_f32 v[32:33], v[32:33], v[20:21] op_sel_hi:[1,0]
    v_pk_mul_f32 v[48:49], v[48:49], v[22:23] op_sel_hi:[1,0]
    v_pk_mul_f32 v[34:35], v[34:35], v[20:21] op_sel_hi:[1,0]
    v_pk_mul_f32 v[50:51], v[50:51], v[22:23] op_sel_hi:[1,0]
    v_pk_mul_f32 v[36:37], v[36:37], v[20:21] op_sel_hi:[1,0]
    v_pk_mul_f32 v[52:53], v[52:53], v[22:23] op_sel_hi:[1,0]
    v_pk_mul_f32 v[38:39], v[38:39], v[20:21] op_sel_hi:[1,0]
    v_pk_mul_f32 v[54:55], v[54:55], v[22:23] op_sel_hi:[1,0]
    v_pk_mul_f32 v[40:41], v[40:41], v[20:21] op_sel_hi:[1,0]
    v_pk_mul_f32 v[56:57], v[56:57], v[22:23] op_sel_hi:[1,0]
    v_pk_mul_f32 v[42:43], v[42:43], v[20:21] op_sel_hi:[1,0]
    v_pk_mul_f32 v[58:59], v[58:59], v[22:23] op_sel_hi:[1,0]
    v_pk_mul_f32 v[44:45], v[44:45], v[20:21] op_sel_hi:[1,0]
    v_pk_mul_f32 v[60:61], v[60:61], v[22:23] op_sel_hi:[1,0]
    v_pk_mul_f32 v[46:47], v[46:47], v[20:21] op_sel_hi:[1,0]
    v_pk_mul_f32 v[62:63], v[62:63], v[22:23] op_sel_hi:[1,0]
    v_cvt_pk_bf16_f32 v96, v32, v33
    v_cvt_pk_bf16_f32 v104, v48, v49
    v_cvt_pk_bf16_f32 v97, v34, v35
    v_cvt_pk_bf16_f32 v105, v50, v51
    v_cvt_pk_bf16_f32 v98, v36, v37
    v_cvt_pk_bf16_f32 v106, v52, v53
    v_cvt_pk_bf16_f32 v99, v38, v39
    v_cvt_pk_bf16_f32 v107, v54, v55
    v_cvt_pk_bf16_f32 v100, v40, v41
    v_cvt_pk_bf16_f32 v108, v56, v57
    v_cvt_pk_bf16_f32 v101, v42, v43
    v_cvt_pk_bf16_f32 v109, v58, v59
    v_cvt_pk_bf16_f32 v102, v44, v45
    v_cvt_pk_bf16_f32 v110, v60, v61
    v_cvt_pk_bf16_f32 v103, v46, v47
    v_cvt_pk_bf16_f32 v111, v62, v63
    v_mfma_f32_32x32x16_bf16 v[32:47], v[96:99], a[112:115], 0
    v_mfma_f32_32x32x16_bf16 v[48:63], v[104:107], a[112:115], 0
    v_mfma_f32_32x32x16_bf16 v[32:47], v[100:103], a[116:119], v[32:47]
    v_mfma_f32_32x32x16_bf16 v[48:63], v[108:111], a[116:119], v[48:63]
    s_lshl_b32 s74, s58, 11
    s_add_u32 s74, s74, 0
    v_add_u32 v11, s74, v10
    s_lshl_b32 s74, s58, 13
    s_add_u32 s74, s74, 0
    v_add_u32_e64 v25, s74, v10
    s_lshl_b32 s75, s57, 4
    s_add_u32 s75, s75, s56
    s_lshl_b32 s75, s75, 2
    s_add_u32 s75, s75, s58
    s_lshl_b32 s75, s75, 10
    s_add_u32 s75, s75, 6291456
    v_cvt_pk_bf16_f32 v64, v32, v33
    v_cvt_pk_bf16_f32 v65, v34, v35
    v_cvt_pk_bf16_f32 v66, v36, v37
    v_cvt_pk_bf16_f32 v67, v38, v39
    v_cvt_pk_bf16_f32 v68, v40, v41
    v_cvt_pk_bf16_f32 v69, v42, v43
    v_cvt_pk_bf16_f32 v70, v44, v45
    v_cvt_pk_bf16_f32 v71, v46, v47
    v_mfma_f32_32x32x16_bf16 v[96:111], v[64:67], v[88:91], 0
    s_nop 0
    s_nop 0
    v_mfma_f32_32x32x16_bf16 v[96:111], v[68:71], v[92:95], v[96:111]
    v_cvt_pk_bf16_f32 v72, v48, v49
    v_cvt_pk_bf16_f32 v73, v50, v51
    v_cvt_pk_bf16_f32 v74, v52, v53
    v_cvt_pk_bf16_f32 v75, v54, v55
    v_cvt_pk_bf16_f32 v76, v56, v57
    v_cvt_pk_bf16_f32 v77, v58, v59
    v_cvt_pk_bf16_f32 v78, v60, v61
    v_cvt_pk_bf16_f32 v79, v62, v63
    v_mfma_f32_32x32x16_bf16 v[112:127], v[72:75], v[88:91], 0
    s_nop 0
    v_mfma_f32_32x32x16_bf16 v[112:127], v[76:79], v[92:95], v[112:127]
    s_nop 0
    ds_write_b128 v11, v[96:99] offset:0
    ds_write_b128 v11, v[100:103] offset:1024
    ds_write_b128 v11, v[104:107] offset:8192
    ds_write_b128 v11, v[108:111] offset:9216
    s_nop 6
    ds_write_b128 v11, v[112:115] offset:16384
    ds_write_b128 v11, v[116:119] offset:17408
    ds_write_b128 v11, v[120:123] offset:24576
    ds_write_b128 v11, v[124:127] offset:25600
    s_waitcnt lgkmcnt(0)
    s_barrier
    s_add_u32 s95, s73, 0
    s_add_u32 m0, s87, 65536
    s_nop 0
    s_nop 0
    buffer_load_dwordx4 v3, s[32:35], s95 offen lds
    ds_read_b128 v[32:35], v25 offset:0
    ds_read_b128 v[36:39], v25 offset:1024
    ds_read_b128 v[40:43], v25 offset:2048
    ds_read_b128 v[44:47], v25 offset:3072
    ds_read_b128 v[48:51], v25 offset:4096
    ds_read_b128 v[52:55], v25 offset:5120
    ds_read_b128 v[56:59], v25 offset:6144
    ds_read_b128 v[60:63], v25 offset:7168
    s_waitcnt lgkmcnt(5)
    v_pk_add_f32 v[32:33], v[32:33], v[40:41]
    v_pk_add_f32 v[34:35], v[34:35], v[42:43]
    s_waitcnt lgkmcnt(4)
    v_pk_add_f32 v[36:37], v[36:37], v[44:45]
    v_pk_add_f32 v[38:39], v[38:39], v[46:47]
    s_waitcnt lgkmcnt(1)
    v_pk_add_f32 v[48:49], v[48:49], v[56:57]
    v_pk_add_f32 v[50:51], v[50:51], v[58:59]
    s_waitcnt lgkmcnt(0)
    v_pk_add_f32 v[52:53], v[52:53], v[60:61]
    v_pk_add_f32 v[54:55], v[54:55], v[62:63]
    v_pk_add_f32 v[32:33], v[32:33], v[48:49]
    v_pk_add_f32 v[34:35], v[34:35], v[50:51]
    v_pk_add_f32 v[36:37], v[36:37], v[52:53]
    v_pk_add_f32 v[38:39], v[38:39], v[54:55]
    v_cvt_pk_bf16_f32 v40, v32, v33
    v_cvt_pk_bf16_f32 v41, v34, v35
    v_cvt_pk_bf16_f32 v42, v36, v37
    v_cvt_pk_bf16_f32 v43, v38, v39
    buffer_store_dwordx4 v[40:43], v10, s[36:39], s75 offen sc0 sc1
    s_lshl_b32 s75, s57, 4
    s_add_u32 s75, s75, s56
    s_lshl_b32 s75, s75, 2
    s_add_u32 s75, s75, 13631488
    v_and_b32 v11, 15, v0
    v_lshrrev_b32 v12, 4, v0
    v_lshrrev_b32 v15, 2, v11
    v_cmp_eq_u32 vcc, v12, v15
    v_mov_b32 v14, 0x3f80
    v_and_b32 v15, 1, v11
    v_lshlrev_b32 v15, 4, v15
    v_lshlrev_b32 v16, v15, v14
    v_cndmask_b32 v16, 0, v16, vcc
    v_and_b32_e64 v15, 2, v11
    v_cmp_eq_u32 vcc, 0, v15
    v_accvgpr_write_b32 a112, 0
    v_accvgpr_write_b32 a113, 0
    v_accvgpr_write_b32 a116, 0
    v_accvgpr_write_b32 a117, 0
    v_cndmask_b32 v17, 0, v16, vcc
    v_cndmask_b32 v18, v16, 0, vcc
    v_accvgpr_write_b32 a114, v17
    v_accvgpr_write_b32 a115, v18
    s_waitcnt vmcnt(0)
    s_barrier
    s_cmp_lg_u32 s58, 0
    s_cbranch_scc1 L_w01
    v_mov_b32 v28, s80
    v_mov_b32_e64 v29, s75
    s_mov_b64 exec, 1
    buffer_store_dword v28, v29, s[36:39], 0 offen sc0 sc1
    s_mov_b64 exec, -1
L_w01:
    s_load_dwordx2 s[4:5], s[0:1], 24
    s_load_dwordx2 s[8:9], s[0:1], 88
    s_min_u32 s88, s3, 223
    s_and_b32 s74, s88, 7
    s_lshl_b32 s74, s74, 2
    s_bfe_u32 s75, s88, 0x20003
    s_add_u32 s89, s74, s75
    s_lshr_b32 s90, s88, 5
    v_lshrrev_b32 v11, 3, v0
    v_mul_u32_u24 v11, 896, v11
    v_and_b32 v12, 7, v0
    v_bfe_u32 v14, v0, 4, 1
    v_lshlrev_b32 v14, 2, v14
    v_xor_b32 v12, v12, v14
    v_lshl_add_u32 v1, v12, 4, v11
    s_mul_i32 s81, s58, 100352
    s_lshl_b32 s74, s90, 7
    s_add_u32 s81, s81, s74
    s_mul_i32 s91, s58, 14336
    s_waitcnt lgkmcnt(0)
    s_mov_b32 s28, s4
    s_and_b32 s29, s5, 0xffff
    s_mov_b32 s30, 401408
    s_mov_b32 s31, 0x20000
    s_mov_b32 s52, s8
    s_and_b32 s53, s9, 0xffff
    s_mov_b32 s54, 3670016
    s_mov_b32 s55, 0x20000
    s_lshr_b32 s74, s2, 3
    s_lshl_b32 s74, s74, 2
    s_add_u32 s74, s74, s58
    s_mul_i32 s74, s74, 25
    v_min_u32 v11, 24, v0
    v_add_u32 v11, s74, v11
    v_lshlrev_b32 v11, 7, v11
    buffer_load_dword v24, v11, s[28:31], 0 offen
    s_lshl_b32 s75, s57, 6
    s_add_u32 s75, s75, 13631488
    v_and_b32 v27, 15, v0
    v_lshlrev_b32 v27, 2, v27
    v_add_u32 v27, s75, v27
    ds_read_b64_tr_b16 v[64:65], v8 offset:24576
    ds_read_b64_tr_b16 v[66:67], v8 offset:24832
    ds_read_b64_tr_b16 v[72:73], v8 offset:25600
    ds_read_b64_tr_b16 v[74:75], v8 offset:25856
    ds_read_b64_tr_b16 v[80:81], v8 offset:26624
    ds_read_b64_tr_b16 v[82:83], v8 offset:26880
    ds_read_b64_tr_b16 v[88:89], v8 offset:27648
    ds_read_b64_tr_b16 v[90:91], v8 offset:27904
    s_waitcnt lgkmcnt(6)
    v_mfma_f32_32x32x16_bf16 v[32:47], v[64:67], a[0:3], 0
    ds_read_b64_tr_b16 v[64:65], v8 offset:28672
    ds_read_b64_tr_b16 v[66:67], v8 offset:28928
    s_waitcnt lgkmcnt(6)
    v_mfma_f32_32x32x16_bf16 v[32:47], v[72:75], a[4:7], v[32:47]
    ds_read_b64_tr_b16 v[72:73], v8 offset:29696
    ds_read_b64_tr_b16 v[74:75], v8 offset:29952
    s_waitcnt lgkmcnt(6)
    v_mfma_f32_32x32x16_bf16 v[32:47], v[80:83], a[8:11], v[32:47]
    ds_read_b64_tr_b16 v[80:81], v8 offset:30720
    ds_read_b64_tr_b16 v[82:83], v8 offset:30976
    s_waitcnt lgkmcnt(6)
    v_mfma_f32_32x32x16_bf16 v[32:47], v[88:91], a[12:15], v[32:47]
    ds_read_b64_tr_b16 v[88:89], v8 offset:31744
    ds_read_b64_tr_b16 v[90:91], v8 offset:32000
    s_waitcnt lgkmcnt(6)
    v_mfma_f32_32x32x16_bf16 v[32:47], v[64:67], a[16:19], v[32:47]
    ds_read_b64_tr_b16 v[64:65], v8 offset:0
    ds_read_b64_tr_b16 v[66:67], v8 offset:256
    s_waitcnt lgkmcnt(6)
    v_mfma_f32_32x32x16_bf16 v[32:47], v[72:75], a[20:23], v[32:47]
    ds_read_b64_tr_b16 v[72:73], v8 offset:1024
    ds_read_b64_tr_b16 v[74:75], v8 offset:1280
    s_waitcnt lgkmcnt(6)
    v_mfma_f32_32x32x16_bf16 v[32:47], v[80:83], a[24:27], v[32:47]
    ds_read_b64_tr_b16 v[80:81], v8 offset:2048
    ds_read_b64_tr_b16 v[82:83], v8 offset:2304
    s_waitcnt lgkmcnt(6)
    v_mfma_f32_32x32x16_bf16 v[32:47], v[88:91], a[28:31], v[32:47]
    ds_read_b64_tr_b16 v[88:89], v8 offset:3072
    ds_read_b64_tr_b16 v[90:91], v8 offset:3328
    s_waitcnt lgkmcnt(6)
    v_mfma_f32_32x32x16_bf16 v[32:47], v[64:67], a[32:35], v[32:47]
    ds_read_b64_tr_b16 v[64:65], v8 offset:4096
    ds_read_b64_tr_b16 v[66:67], v8 offset:4352
    s_waitcnt lgkmcnt(6)
    v_mfma_f32_32x32x16_bf16 v[32:47], v[72:75], a[36:39], v[32:47]
    ds_read_b64_tr_b16 v[72:73], v8 offset:5120
    ds_read_b64_tr_b16 v[74:75], v8 offset:5376
    s_waitcnt lgkmcnt(6)
    v_mfma_f32_32x32x16_bf16 v[32:47], v[80:83], a[40:43], v[32:47]
    ds_read_b64_tr_b16 v[80:81], v8 offset:6144
    ds_read_b64_tr_b16 v[82:83], v8 offset:6400
    s_waitcnt lgkmcnt(6)
    v_mfma_f32_32x32x16_bf16 v[32:47], v[88:91], a[44:47], v[32:47]
    ds_read_b64_tr_b16 v[88:89], v8 offset:7168
    ds_read_b64_tr_b16 v[90:91], v8 offset:7424
    s_waitcnt lgkmcnt(6)
    v_mfma_f32_32x32x16_bf16 v[32:47], v[64:67], a[48:51], v[32:47]
    ds_read_b64_tr_b16 v[64:65], v8 offset:8192
    ds_read_b64_tr_b16 v[66:67], v8 offset:8448
    s_waitcnt lgkmcnt(6)
    v_mfma_f32_32x32x16_bf16 v[32:47], v[72:75], a[52:55], v[32:47]
    ds_read_b64_tr_b16 v[72:73], v8 offset:9216
    ds_read_b64_tr_b16 v[74:75], v8 offset:9472
    s_waitcnt lgkmcnt(6)
    v_mfma_f32_32x32x16_bf16 v[32:47], v[80:83], a[56:59], v[32:47]
    ds_read_b64_tr_b16 v[80:81], v8 offset:10240
    ds_read_b64_tr_b16 v[82:83], v8 offset:10496
    s_waitcnt lgkmcnt(6)
    v_mfma_f32_32x32x16_bf16 v[32:47], v[88:91], a[60:63], v[32:47]
    ds_read_b64_tr_b16 v[88:89], v8 offset:11264
    ds_read_b64_tr_b16 v[90:91], v8 offset:11520
    s_waitcnt lgkmcnt(6)
    v_mfma_f32_32x32x16_bf16 v[32:47], v[64:67], a[64:67], v[32:47]
    ds_read_b64_tr_b16 v[64:65], v8 offset:12288
    ds_read_b64_tr_b16 v[66:67], v8 offset:12544
    s_waitcnt lgkmcnt(6)
    v_mfma_f32_32x32x16_bf16 v[32:47], v[72:75], a[68:71], v[32:47]
    ds_read_b64_tr_b16 v[72:73], v8 offset:13312
    ds_read_b64_tr_b16 v[74:75], v8 offset:13568
    s_waitcnt lgkmcnt(6)
    v_mfma_f32_32x32x16_bf16 v[32:47], v[80:83], a[72:75], v[32:47]
    ds_read_b64_tr_b16 v[80:81], v8 offset:14336
    ds_read_b64_tr_b16 v[82:83], v8 offset:14592
    s_waitcnt lgkmcnt(6)
    v_mfma_f32_32x32x16_bf16 v[32:47], v[88:91], a[76:79], v[32:47]
    ds_read_b64_tr_b16 v[88:89], v8 offset:15360
    ds_read_b64_tr_b16 v[90:91], v8 offset:15616
    s_waitcnt lgkmcnt(6)
    v_mfma_f32_32x32x16_bf16 v[32:47], v[64:67], a[80:83], v[32:47]
    ds_read_b64_tr_b16 v[64:65], v8 offset:16384
    ds_read_b64_tr_b16 v[66:67], v8 offset:16640
    s_waitcnt lgkmcnt(6)
    v_mfma_f32_32x32x16_bf16 v[32:47], v[72:75], a[84:87], v[32:47]
    ds_read_b64_tr_b16 v[72:73], v8 offset:17408
    ds_read_b64_tr_b16 v[74:75], v8 offset:17664
    s_waitcnt lgkmcnt(6)
    v_mfma_f32_32x32x16_bf16 v[32:47], v[80:83], a[88:91], v[32:47]
    ds_read_b64_tr_b16 v[80:81], v8 offset:18432
    ds_read_b64_tr_b16 v[82:83], v8 offset:18688
    s_waitcnt lgkmcnt(6)
    v_mfma_f32_32x32x16_bf16 v[32:47], v[88:91], a[92:95], v[32:47]
    ds_read_b64_tr_b16 v[88:89], v8 offset:19456
    ds_read_b64_tr_b16 v[90:91], v8 offset:19712
    s_waitcnt lgkmcnt(6)
    v_mfma_f32_32x32x16_bf16 v[32:47], v[64:67], a[96:99], v[32:47]
    s_waitcnt lgkmcnt(4)
    v_mfma_f32_32x32x16_bf16 v[32:47], v[72:75], a[100:103], v[32:47]
    s_waitcnt lgkmcnt(2)
    v_mfma_f32_32x32x16_bf16 v[32:47], v[80:83], a[104:107], v[32:47]
    s_waitcnt lgkmcnt(0)
    v_mfma_f32_32x32x16_bf16 v[32:47], v[88:91], a[108:111], v[32:47]
    s_barrier
    s_waitcnt vmcnt(0)
    s_cmp_lg_u32 s58, 0
    s_cbranch_scc1 L_w02
    s_sleep 4
    s_mov_b32 s76, 400000
L_pr3:
    buffer_load_dword v26, v27, s[36:39], 0 offen sc0 sc1
    s_waitcnt vmcnt(0)
    v_cmp_ne_u32 vcc, s80, v26
    s_nop 1
    s_cbranch_vccz L_pr3_done
    s_sleep 4
    s_sub_u32 s76, s76, 1
    s_cmp_lg_u32 s76, 0
    s_cbranch_scc1 L_pr3
L_pr3_done:
L_w02:
    s_barrier
    s_lshl_b32 s74, s57, 6
    s_add_u32 s74, s74, s58
    s_lshl_b32 s74, s74, 10
    s_nop 0
    s_add_u32 s74, s74, 6291456
    buffer_load_dwordx4 a[0:3], v10, s[36:39], s74 offen sc0 sc1
    s_add_u32 s74, s74, 4096
    buffer_load_dwordx4 a[4:7], v10, s[36:39], s74 offen sc0 sc1
    s_add_u32 s74, s74, 4096
    buffer_load_dwordx4 a[8:11], v10, s[36:39], s74 offen sc0 sc1
    s_add_u32 s74, s74, 4096
    buffer_load_dwordx4 a[12:15], v10, s[36:39], s74 offen sc0 sc1
    s_add_u32 s74, s74, 4096
    buffer_load_dwordx4 a[16:19], v10, s[36:39], s74 offen sc0 sc1
    s_add_u32 s74, s74, 4096
    buffer_load_dwordx4 a[20:23], v10, s[36:39], s74 offen sc0 sc1
    s_add_u32 s74, s74, 4096
    buffer_load_dwordx4 a[24:27], v10, s[36:39], s74 offen sc0 sc1
    s_add_u32 s74, s74, 4096
    buffer_load_dwordx4 a[28:31], v10, s[36:39], s74 offen sc0 sc1
    s_add_u32 s74, s74, 4096
    buffer_load_dwordx4 a[32:35], v10, s[36:39], s74 offen sc0 sc1
    s_add_u32 s74, s74, 4096
    buffer_load_dwordx4 a[36:39], v10, s[36:39], s74 offen sc0 sc1
    s_add_u32 s74, s74, 4096
    buffer_load_dwordx4 a[40:43], v10, s[36:39], s74 offen sc0 sc1
    s_add_u32 s74, s74, 4096
    buffer_load_dwordx4 a[44:47], v10, s[36:39], s74 offen sc0 sc1
    s_add_u32 s74, s74, 4096
    buffer_load_dwordx4 a[48:51], v10, s[36:39], s74 offen sc0 sc1
    s_add_u32 s74, s74, 4096
    buffer_load_dwordx4 a[52:55], v10, s[36:39], s74 offen sc0 sc1
    s_add_u32 s74, s74, 4096
    buffer_load_dwordx4 a[56:59], v10, s[36:39], s74 offen sc0 sc1
    s_add_u32 s74, s74, 4096
    buffer_load_dwordx4 a[60:63], v10, s[36:39], s74 offen sc0 sc1
    v_cvt_pk_bf16_f32 v64, v32, v33
    v_cvt_pk_bf16_f32 v65, v34, v35
    v_cvt_pk_bf16_f32 v66, v36, v37
    v_cvt_pk_bf16_f32 v67, v38, v39
    v_cvt_pk_bf16_f32 v68, v40, v41
    v_cvt_pk_bf16_f32 v69, v42, v43
    v_cvt_pk_bf16_f32 v70, v44, v45
    v_cvt_pk_bf16_f32 v71, v46, v47
    v_mfma_f32_32x32x16_bf16 v[72:87], a[120:123], v[64:67], 0
    s_nop 0
    v_mfma_f32_32x32x16_bf16 v[72:87], a[124:127], v[68:71], v[72:87]
    s_nop 11
    v_max3_f32 v12, v72, v73, v74
    v_min3_f32 v14, v72, v73, v74
    v_max3_f32 v12, v12, v75, v76
    v_min3_f32 v14, v14, v75, v76
    v_max3_f32 v12, v12, v77, v78
    v_min3_f32 v14, v14, v77, v78
    v_max3_f32 v12, v12, v79, v80
    v_min3_f32 v14, v14, v79, v80
    v_max3_f32 v12, v12, v81, v82
    v_min3_f32 v14, v14, v81, v82
    v_max3_f32 v12, v12, v83, v84
    v_min3_f32 v14, v14, v83, v84
    v_max3_f32 v12, v12, v85, v86
    v_min3_f32 v14, v14, v85, v86
    v_max_f32 v12, v12, v87
    v_min_f32 v14, v14, v87
    v_mov_b32 v16, v12
    v_mov_b32 v18, v14
    s_nop 0
    v_permlane32_swap_b32 v12, v16
    v_permlane32_swap_b32 v14, v18
    v_max_f32 v12, v12, v16
    v_min_f32 v14, v14, v18
    v_mul_f32 v12, s78, v12
    v_mul_f32_e64 v14, s78, v14
    v_pk_fma_f32 v[32:33], v[72:73], s[78:79], v[12:13] op_sel_hi:[1,1,0] neg_lo:[0,0,1] neg_hi:[0,0,1]
    v_pk_fma_f32 v[48:49], v[72:73], s[78:79], v[14:15] op_sel_hi:[1,1,0] neg_lo:[1,0,0] neg_hi:[1,0,0]
    v_pk_fma_f32 v[34:35], v[74:75], s[78:79], v[12:13] op_sel_hi:[1,1,0] neg_lo:[0,0,1] neg_hi:[0,0,1]
    v_pk_fma_f32 v[50:51], v[74:75], s[78:79], v[14:15] op_sel_hi:[1,1,0] neg_lo:[1,0,0] neg_hi:[1,0,0]
    v_pk_fma_f32 v[36:37], v[76:77], s[78:79], v[12:13] op_sel_hi:[1,1,0] neg_lo:[0,0,1] neg_hi:[0,0,1]
    v_pk_fma_f32 v[52:53], v[76:77], s[78:79], v[14:15] op_sel_hi:[1,1,0] neg_lo:[1,0,0] neg_hi:[1,0,0]
    v_pk_fma_f32 v[38:39], v[78:79], s[78:79], v[12:13] op_sel_hi:[1,1,0] neg_lo:[0,0,1] neg_hi:[0,0,1]
    v_pk_fma_f32 v[54:55], v[78:79], s[78:79], v[14:15] op_sel_hi:[1,1,0] neg_lo:[1,0,0] neg_hi:[1,0,0]
    v_pk_fma_f32 v[40:41], v[80:81], s[78:79], v[12:13] op_sel_hi:[1,1,0] neg_lo:[0,0,1] neg_hi:[0,0,1]
    v_pk_fma_f32 v[56:57], v[80:81], s[78:79], v[14:15] op_sel_hi:[1,1,0] neg_lo:[1,0,0] neg_hi:[1,0,0]
    v_pk_fma_f32 v[42:43], v[82:83], s[78:79], v[12:13] op_sel_hi:[1,1,0] neg_lo:[0,0,1] neg_hi:[0,0,1]
    v_pk_fma_f32 v[58:59], v[82:83], s[78:79], v[14:15] op_sel_hi:[1,1,0] neg_lo:[1,0,0] neg_hi:[1,0,0]
    v_pk_fma_f32 v[44:45], v[84:85], s[78:79], v[12:13] op_sel_hi:[1,1,0] neg_lo:[0,0,1] neg_hi:[0,0,1]
    v_pk_fma_f32 v[60:61], v[84:85], s[78:79], v[14:15] op_sel_hi:[1,1,0] neg_lo:[1,0,0] neg_hi:[1,0,0]
    v_pk_fma_f32 v[46:47], v[86:87], s[78:79], v[12:13] op_sel_hi:[1,1,0] neg_lo:[0,0,1] neg_hi:[0,0,1]
    v_pk_fma_f32 v[62:63], v[86:87], s[78:79], v[14:15] op_sel_hi:[1,1,0] neg_lo:[1,0,0] neg_hi:[1,0,0]
    v_exp_f32 v32, v32
    v_exp_f32 v48, v48
    v_exp_f32 v33, v33
    v_exp_f32 v49, v49
    v_exp_f32 v34, v34
    v_exp_f32 v50, v50
    v_exp_f32 v35, v35
    v_exp_f32 v51, v51
    v_exp_f32 v36, v36
    v_exp_f32 v52, v52
    v_exp_f32 v37, v37
    v_exp_f32 v53, v53
    v_exp_f32 v38, v38
    v_exp_f32 v54, v54
    v_exp_f32 v39, v39
    v_exp_f32 v55, v55
    v_exp_f32 v40, v40
    v_exp_f32 v56, v56
    v_exp_f32 v41, v41
    v_exp_f32 v57, v57
    v_exp_f32 v42, v42
    v_exp_f32 v58, v58
    v_exp_f32 v43, v43
    v_exp_f32 v59, v59
    v_exp_f32 v44, v44
    v_exp_f32 v60, v60
    v_exp_f32 v45, v45
    v_exp_f32 v61, v61
    v_exp_f32 v46, v46
    v_exp_f32 v62, v62
    v_exp_f32 v47, v47
    v_exp_f32 v63, v63
    v_cndmask_b32 v44, v44, 0, s[84:85]
    v_cndmask_b32 v60, v60, 0, s[84:85]
    v_cndmask_b32 v45, v45, 0, s[84:85]
    v_cndmask_b32 v61, v61, 0, s[84:85]
    v_cndmask_b32 v46, v46, 0, s[84:85]
    v_cndmask_b32 v62, v62, 0, s[84:85]
    v_cndmask_b32 v47, v47, 0, s[84:85]
    v_cndmask_b32 v63, v63, 0, s[84:85]
    v_pk_add_f32 v[20:21], v[32:33], v[34:35]
    v_pk_add_f32 v[22:23], v[48:49], v[50:51]
    s_waitcnt vmcnt(15)
    v_mfma_f32_16x16x32_bf16 v[4:7], a[114:117], a[0:3], 0
    v_pk_add_f32 v[20:21], v[20:21], v[36:37]
    v_mfma_f32_16x16x32_bf16 v[28:31], a[112:115], a[0:3], 0
    v_pk_add_f32 v[22:23], v[22:23], v[52:53]
    v_pk_add_f32 v[20:21], v[20:21], v[38:39]
    s_waitcnt vmcnt(14)
    v_mfma_f32_16x16x32_bf16 v[4:7], a[114:117], a[4:7], v[4:7]
    v_pk_add_f32 v[22:23], v[22:23], v[54:55]
    v_pk_add_f32 v[20:21], v[20:21], v[40:41]
    v_mfma_f32_16x16x32_bf16 v[28:31], a[112:115], a[4:7], v[28:31]
    v_pk_add_f32 v[22:23], v[22:23], v[56:57]
    s_waitcnt vmcnt(13)
    v_mfma_f32_16x16x32_bf16 v[4:7], a[114:117], a[8:11], v[4:7]
    v_pk_add_f32 v[20:21], v[20:21], v[42:43]
    v_pk_add_f32 v[22:23], v[22:23], v[58:59]
    v_mfma_f32_16x16x32_bf16 v[28:31], a[112:115], a[8:11], v[28:31]
    v_pk_add_f32 v[20:21], v[20:21], v[44:45]
    v_pk_add_f32 v[22:23], v[22:23], v[60:61]
    s_waitcnt vmcnt(12)
    v_mfma_f32_16x16x32_bf16 v[4:7], a[114:117], a[12:15], v[4:7]
    v_pk_add_f32 v[20:21], v[20:21], v[46:47]
    v_mfma_f32_16x16x32_bf16 v[28:31], a[112:115], a[12:15], v[28:31]
    v_pk_add_f32 v[22:23], v[22:23], v[62:63]
    v_add_f32 v20, v20, v21
    s_waitcnt vmcnt(11)
    v_mfma_f32_16x16x32_bf16 v[4:7], a[114:117], a[16:19], v[4:7]
    v_add_f32 v22, v22, v23
    v_mov_b32 v16, v20
    v_mfma_f32_16x16x32_bf16 v[28:31], a[112:115], a[16:19], v[28:31]
    v_mov_b32 v18, v22
    s_waitcnt vmcnt(10)
    v_mfma_f32_16x16x32_bf16 v[4:7], a[114:117], a[20:23], v[4:7]
    v_permlane32_swap_b32 v20, v16
    v_permlane32_swap_b32 v22, v18
    v_mfma_f32_16x16x32_bf16 v[28:31], a[112:115], a[20:23], v[28:31]
    v_add_f32 v20, v20, v16
    v_add_f32 v22, v22, v18
    s_waitcnt vmcnt(9)
    v_mfma_f32_16x16x32_bf16 v[4:7], a[114:117], a[24:27], v[4:7]
    v_rcp_f32 v20, v20
    v_mfma_f32_16x16x32_bf16 v[28:31], a[112:115], a[24:27], v[28:31]
    v_rcp_f32_e64 v22, v22
    v_pk_mul_f32 v[32:33], v[32:33], v[20:21] op_sel_hi:[1,0]
    s_waitcnt vmcnt(8)
    v_mfma_f32_16x16x32_bf16 v[4:7], a[114:117], a[28:31], v[4:7]
    v_pk_mul_f32 v[48:49], v[48:49], v[22:23] op_sel_hi:[1,0]
    v_pk_mul_f32 v[34:35], v[34:35], v[20:21] op_sel_hi:[1,0]
    v_mfma_f32_16x16x32_bf16 v[28:31], a[112:115], a[28:31], v[28:31]
    v_pk_mul_f32 v[50:51], v[50:51], v[22:23] op_sel_hi:[1,0]
    v_pk_mul_f32 v[36:37], v[36:37], v[20:21] op_sel_hi:[1,0]
    s_waitcnt vmcnt(7)
    v_mfma_f32_16x16x32_bf16 v[4:7], a[114:117], a[32:35], v[4:7]
    v_pk_mul_f32 v[52:53], v[52:53], v[22:23] op_sel_hi:[1,0]
    v_mfma_f32_16x16x32_bf16 v[28:31], a[112:115], a[32:35], v[28:31]
    v_pk_mul_f32 v[38:39], v[38:39], v[20:21] op_sel_hi:[1,0]
    v_pk_mul_f32 v[54:55], v[54:55], v[22:23] op_sel_hi:[1,0]
    s_waitcnt vmcnt(6)
    v_mfma_f32_16x16x32_bf16 v[4:7], a[114:117], a[36:39], v[4:7]
    v_pk_mul_f32 v[40:41], v[40:41], v[20:21] op_sel_hi:[1,0]
    v_pk_mul_f32 v[56:57], v[56:57], v[22:23] op_sel_hi:[1,0]
    v_mfma_f32_16x16x32_bf16 v[28:31], a[112:115], a[36:39], v[28:31]
    v_pk_mul_f32 v[42:43], v[42:43], v[20:21] op_sel_hi:[1,0]
    s_waitcnt vmcnt(5)
    v_mfma_f32_16x16x32_bf16 v[4:7], a[114:117], a[40:43], v[4:7]
    v_pk_mul_f32 v[58:59], v[58:59], v[22:23] op_sel_hi:[1,0]
    v_pk_mul_f32 v[44:45], v[44:45], v[20:21] op_sel_hi:[1,0]
    v_mfma_f32_16x16x32_bf16 v[28:31], a[112:115], a[40:43], v[28:31]
    v_pk_mul_f32 v[60:61], v[60:61], v[22:23] op_sel_hi:[1,0]
    v_pk_mul_f32 v[46:47], v[46:47], v[20:21] op_sel_hi:[1,0]
    s_waitcnt vmcnt(4)
    v_mfma_f32_16x16x32_bf16 v[4:7], a[114:117], a[44:47], v[4:7]
    v_pk_mul_f32 v[62:63], v[62:63], v[22:23] op_sel_hi:[1,0]
    v_mfma_f32_16x16x32_bf16 v[28:31], a[112:115], a[44:47], v[28:31]
    v_cvt_pk_bf16_f32 v112, v32, v33
    v_cvt_pk_bf16_f32 v120, v48, v49
    s_waitcnt vmcnt(3)
    v_mfma_f32_16x16x32_bf16 v[4:7], a[114:117], a[48:51], v[4:7]
    v_cvt_pk_bf16_f32 v113, v34, v35
    v_cvt_pk_bf16_f32 v121, v50, v51
    v_mfma_f32_16x16x32_bf16 v[28:31], a[112:115], a[48:51], v[28:31]
    v_cvt_pk_bf16_f32 v114, v36, v37
    s_waitcnt vmcnt(2)
    v_mfma_f32_16x16x32_bf16 v[4:7], a[114:117], a[52:55], v[4:7]
    v_cvt_pk_bf16_f32 v122, v52, v53
    v_cvt_pk_bf16_f32 v115, v38, v39
    v_mfma_f32_16x16x32_bf16 v[28:31], a[112:115], a[52:55], v[28:31]
    v_cvt_pk_bf16_f32 v123, v54, v55
    v_cvt_pk_bf16_f32 v116, v40, v41
    s_waitcnt vmcnt(1)
    v_mfma_f32_16x16x32_bf16 v[4:7], a[114:117], a[56:59], v[4:7]
    v_cvt_pk_bf16_f32 v124, v56, v57
    v_mfma_f32_16x16x32_bf16 v[28:31], a[112:115], a[56:59], v[28:31]
    v_cvt_pk_bf16_f32 v117, v42, v43
    v_cvt_pk_bf16_f32 v125, v58, v59
    s_waitcnt vmcnt(0)
    v_mfma_f32_16x16x32_bf16 v[4:7], a[114:117], a[60:63], v[4:7]
    v_cvt_pk_bf16_f32 v118, v44, v45
    v_cvt_pk_bf16_f32 v126, v60, v61
    v_mfma_f32_16x16x32_bf16 v[28:31], a[112:115], a[60:63], v[28:31]
    v_cvt_pk_bf16_f32 v119, v46, v47
    v_cvt_pk_bf16_f32 v127, v62, v63
    s_lshl_b32 s74, s58, 10
    s_add_u32 s74, s74, 57344
    v_add_u32_e64 v11, s74, v10
    v_add_u32 v25, 57344, v10
    s_lshl_b32 s77, s56, 2
    s_add_u32 s77, s77, s58
    s_mul_i32 s77, s77, 34816
    s_lshl_b32 s76, s57, 11
    s_add_u32 s77, s77, s76
    s_add_u32 s77, s77, 10485760
    v_cvt_pk_bf16_f32 v40, v4, v5
    v_cvt_pk_bf16_f32 v41, v6, v7
    v_cvt_pk_bf16_f32 v42, v28, v29
    v_cvt_pk_bf16_f32 v43, v30, v31
    ds_write_b128 v11, v[40:43]
    s_waitcnt lgkmcnt(0)
    s_barrier
    ds_read_b128 v[44:47], v25 offset:0
    ds_read_b128 v[48:51], v25 offset:1024
    ds_read_b128 v[52:55], v25 offset:2048
    ds_read_b128 v[56:59], v25 offset:3072
    s_waitcnt lgkmcnt(3)
    v_mfma_f32_32x32x16_bf16 v[64:79], v[44:47], v[112:115], 0
    s_waitcnt lgkmcnt(2)
    v_mfma_f32_32x32x16_bf16 v[64:79], v[48:51], v[116:119], v[64:79]
    s_waitcnt lgkmcnt(1)
    v_mfma_f32_32x32x16_bf16 v[64:79], v[52:55], v[120:123], v[64:79]
    s_waitcnt lgkmcnt(0)
    v_mfma_f32_32x32x16_bf16 v[64:79], v[56:59], v[124:127], v[64:79]
    s_nop 11
    v_mov_b32 v12, v76
    v_mov_b32 v13, v76
    s_nop 1
    v_permlane32_swap_b32 v12, v13
    v_add_f32 v12, 0x358637bd, v12
    v_rcp_f32_e64 v12, v12
    s_nop 0
    v_pk_mul_f32 v[64:65], v[64:65], v[12:13] op_sel_hi:[1,0]
    v_pk_mul_f32 v[66:67], v[66:67], v[12:13] op_sel_hi:[1,0]
    v_pk_mul_f32 v[68:69], v[68:69], v[12:13] op_sel_hi:[1,0]
    v_pk_mul_f32 v[70:71], v[70:71], v[12:13] op_sel_hi:[1,0]
    v_pk_mul_f32 v[72:73], v[72:73], v[12:13] op_sel_hi:[1,0]
    v_pk_mul_f32 v[74:75], v[74:75], v[12:13] op_sel_hi:[1,0]
    v_pk_mul_f32 v[76:77], v[76:77], v[12:13] op_sel_hi:[1,0]
    v_pk_mul_f32 v[78:79], v[78:79], v[12:13] op_sel_hi:[1,0]
    v_cndmask_b32 v76, 0, v76, s[84:85]
    v_cndmask_b32 v77, 0, v77, s[84:85]
    v_cndmask_b32 v78, 0, v78, s[84:85]
    v_cndmask_b32 v79, 0, v79, s[84:85]
    v_cvt_pk_bf16_f32 v80, v64, v65
    v_cvt_pk_bf16_f32 v81, v66, v67
    v_cvt_pk_bf16_f32 v82, v68, v69
    v_cvt_pk_bf16_f32 v83, v70, v71
    v_cvt_pk_bf16_f32 v84, v72, v73
    v_cvt_pk_bf16_f32 v85, v74, v75
    v_cvt_pk_bf16_f32 v86, v76, v77
    v_cvt_pk_bf16_f32 v87, v78, v79
    buffer_store_dwordx4 v[80:83], v10, s[36:39], s77 offen sc0 sc1
    buffer_store_dwordx4 v[84:87], v10, s[36:39], s77 offen offset:1024 sc0 sc1
    s_and_b32 s76, s58, 1
    s_lshr_b32 s77, s58, 1
    s_lshl_b32 s74, s76, 15
    v_lshl_add_u32 v11, v0, 4, s74
    v_and_b32 v12, 15, v0
    v_lshrrev_b32 v14, 4, v0
    v_lshrrev_b32 v15, 2, v12
    v_lshrrev_b32 v16, 1, v15
    v_xor_b32 v16, s77, v16
    v_lshlrev_b32 v16, 6, v16
    v_and_b32 v17, 1, v14
    v_lshl_add_u32 v16, v17, 5, v16
    v_and_b32 v17, 3, v12
    v_lshl_add_u32 v16, v17, 3, v16
    v_lshrrev_b32 v17, 1, v14
    v_lshl_add_u32 v17, v17, 2, v15
    v_lshl_add_u32 v15, v17, 7, v16
    v_and_b32 v2, 31, v0
    v_lshrrev_b32 v3, 5, v0
    s_lshl_b32 s74, s89, 6
    s_lshl_b32 s75, s76, 5
    s_add_u32 s74, s74, s75
    v_add_u32 v2, s74, v2
    v_mul_u32_u24 v2, 1792, v2
    v_lshl_add_u32 v2, v3, 4, v2
    s_lshl_b32 s59, s90, 7
    s_lshl_b32 s74, s77, 6
    s_add_u32 s59, s59, s74
    s_lshl_b32 s75, s56, 4
    s_add_u32 s75, s75, s57
    s_lshl_b32 s75, s75, 2
    s_add_u32 s75, s75, 14024704
    s_waitcnt vmcnt(0)
    s_barrier
    s_cmp_lg_u32 s58, 0
    s_cbranch_scc1 L_w04
    v_mov_b32 v28, s80
    v_mov_b32 v29, s75
    s_mov_b64 exec, 1
    buffer_store_dword v28, v29, s[36:39], 0 offen sc0 sc1
    s_mov_b64 exec, -1
L_w04:
    s_cmp_ge_u32 s2, 224
    s_cbranch_scc1 L_a_fin
    s_add_u32 s95, s81, 0
    s_add_u32 m0, s91, 0
    s_nop 0
    buffer_load_dwordx4 v1, s[28:31], s95 offen lds
    s_add_u32 s95, s81, 7168
    s_add_u32 m0, s91, 1024
    s_nop 0
    buffer_load_dwordx4 v1, s[28:31], s95 offen lds
    s_add_u32 s95, s81, 14336
    s_add_u32 m0, s91, 2048
    s_nop 0
    buffer_load_dwordx4 v1, s[28:31], s95 offen lds
    s_add_u32 s95, s81, 21504
    s_add_u32 m0, s91, 3072
    s_nop 0
    buffer_load_dwordx4 v1, s[28:31], s95 offen lds
    s_add_u32 s95, s81, 28672
    s_add_u32 m0, s91, 4096
    s_nop 0
    buffer_load_dwordx4 v1, s[28:31], s95 offen lds
    s_add_u32 s95, s81, 35840
    s_add_u32 m0, s91, 5120
    s_nop 0
    buffer_load_dwordx4 v1, s[28:31], s95 offen lds
    s_add_u32 s95, s81, 43008
    s_add_u32 m0, s91, 6144
    s_nop 0
    buffer_load_dwordx4 v1, s[28:31], s95 offen lds
    s_add_u32 s95, s81, 50176
    s_add_u32 m0, s91, 7168
    s_nop 0
    buffer_load_dwordx4 v1, s[28:31], s95 offen lds
    s_add_u32 s95, s81, 57344
    s_add_u32 m0, s91, 8192
    s_nop 0
    buffer_load_dwordx4 v1, s[28:31], s95 offen lds
    s_add_u32 s95, s81, 64512
    s_add_u32 m0, s91, 9216
    s_nop 0
    buffer_load_dwordx4 v1, s[28:31], s95 offen lds
    s_add_u32 s95, s81, 71680
    s_add_u32 m0, s91, 10240
    s_nop 0
    buffer_load_dwordx4 v1, s[28:31], s95 offen lds
    s_add_u32 s95, s81, 78848
    s_add_u32 m0, s91, 11264
    s_nop 0
    buffer_load_dwordx4 v1, s[28:31], s95 offen lds
    s_add_u32 s95, s81, 86016
    s_add_u32 m0, s91, 12288
    s_nop 0
    buffer_load_dwordx4 v1, s[28:31], s95 offen lds
    s_add_u32 s95, s81, 93184
    s_add_u32 m0, s91, 13312
    s_nop 0
    buffer_load_dwordx4 v1, s[28:31], s95 offen lds
    s_lshr_b32 s75, s89, 1
    s_lshl_b32 s75, s75, 6
    s_add_u32 s75, s75, 14024704
    v_and_b32 v27, 15, v0
    v_lshlrev_b32 v27, 2, v27
    v_add_u32 v27, s75, v27
    s_waitcnt vmcnt(0)
    s_barrier
    ds_read_b64_tr_b16 a[0:1], v15 offset:0
    ds_read_b64_tr_b16 a[2:3], v15 offset:1024
    ds_read_b64_tr_b16 a[4:5], v15 offset:2048
    ds_read_b64_tr_b16 a[6:7], v15 offset:2560
    ds_read_b64_tr_b16 a[8:9], v15 offset:3584
    ds_read_b64_tr_b16 a[10:11], v15 offset:4608
    ds_read_b64_tr_b16 a[12:13], v15 offset:5632
    ds_read_b64_tr_b16 a[14:15], v15 offset:6144
    ds_read_b64_tr_b16 a[16:17], v15 offset:7168
    ds_read_b64_tr_b16 a[18:19], v15 offset:8192
    ds_read_b64_tr_b16 a[20:21], v15 offset:9216
    ds_read_b64_tr_b16 a[22:23], v15 offset:9728
    ds_read_b64_tr_b16 a[24:25], v15 offset:10752
    ds_read_b64_tr_b16 a[26:27], v15 offset:11776
    ds_read_b64_tr_b16 a[28:29], v15 offset:12800
    ds_read_b64_tr_b16 a[30:31], v15 offset:13312
    ds_read_b64_tr_b16 a[32:33], v15 offset:14336
    ds_read_b64_tr_b16 a[34:35], v15 offset:15360
    ds_read_b64_tr_b16 a[36:37], v15 offset:16384
    ds_read_b64_tr_b16 a[38:39], v15 offset:16896
    ds_read_b64_tr_b16 a[40:41], v15 offset:17920
    ds_read_b64_tr_b16 a[42:43], v15 offset:18944
    ds_read_b64_tr_b16 a[44:45], v15 offset:19968
    ds_read_b64_tr_b16 a[46:47], v15 offset:20480
    ds_read_b64_tr_b16 a[48:49], v15 offset:21504
    ds_read_b64_tr_b16 a[50:51], v15 offset:22528
    ds_read_b64_tr_b16 a[52:53], v15 offset:23552
    ds_read_b64_tr_b16 a[54:55], v15 offset:24064
    ds_read_b64_tr_b16 a[56:57], v15 offset:25088
    ds_read_b64_tr_b16 a[58:59], v15 offset:26112
    ds_read_b64_tr_b16 a[60:61], v15 offset:27136
    ds_read_b64_tr_b16 a[62:63], v15 offset:27648
    ds_read_b64_tr_b16 a[64:65], v15 offset:28672
    ds_read_b64_tr_b16 a[66:67], v15 offset:29696
    ds_read_b64_tr_b16 a[68:69], v15 offset:30720
    ds_read_b64_tr_b16 a[70:71], v15 offset:31232
    ds_read_b64_tr_b16 a[72:73], v15 offset:32256
    ds_read_b64_tr_b16 a[74:75], v15 offset:33280
    ds_read_b64_tr_b16 a[76:77], v15 offset:34304
    ds_read_b64_tr_b16 a[78:79], v15 offset:34816
    ds_read_b64_tr_b16 a[80:81], v15 offset:35840
    ds_read_b64_tr_b16 a[82:83], v15 offset:36864
    ds_read_b64_tr_b16 a[84:85], v15 offset:37888
    ds_read_b64_tr_b16 a[86:87], v15 offset:38400
    ds_read_b64_tr_b16 a[88:89], v15 offset:39424
    ds_read_b64_tr_b16 a[90:91], v15 offset:40448
    ds_read_b64_tr_b16 a[92:93], v15 offset:41472
    ds_read_b64_tr_b16 a[94:95], v15 offset:41984
    ds_read_b64_tr_b16 a[96:97], v15 offset:43008
    ds_read_b64_tr_b16 a[98:99], v15 offset:44032
    ds_read_b64_tr_b16 a[100:101], v15 offset:45056
    ds_read_b64_tr_b16 a[102:103], v15 offset:45568
    ds_read_b64_tr_b16 a[104:105], v15 offset:46592
    ds_read_b64_tr_b16 a[106:107], v15 offset:47616
    ds_read_b64_tr_b16 a[108:109], v15 offset:48640
    ds_read_b64_tr_b16 a[110:111], v15 offset:49152
    ds_read_b64_tr_b16 a[112:113], v15 offset:50176
    ds_read_b64_tr_b16 a[114:115], v15 offset:51200
    ds_read_b64_tr_b16 a[116:117], v15 offset:52224
    ds_read_b64_tr_b16 a[118:119], v15 offset:52736
    ds_read_b64_tr_b16 a[120:121], v15 offset:53760
    ds_read_b64_tr_b16 a[122:123], v15 offset:54784
    ds_read_b64_tr_b16 a[124:125], v15 offset:55808
    ds_read_b64_tr_b16 a[126:127], v15 offset:56320
    s_waitcnt lgkmcnt(0)
    s_cmp_lg_u32 s58, 0
    s_cbranch_scc1 L_w05
    s_mov_b32 s76, 400000
L_pr6:
    buffer_load_dword v26, v27, s[36:39], 0 offen sc0 sc1
    s_waitcnt vmcnt(0)
    v_cmp_ne_u32 vcc, s80, v26
    s_nop 1
    s_cbranch_vccz L_pr6_done
    s_sleep 4
    s_sub_u32 s76, s76, 1
    s_cmp_lg_u32 s76, 0
    s_cbranch_scc1 L_pr6
L_pr6_done:
L_w05:
    s_barrier
    s_lshr_b32 s74, s58, 1
    s_lshl_b32 s74, s74, 15
    s_and_b32 s75, s58, 1
    s_lshl_b32 s75, s75, 12
    s_add_u32 s75, s75, s74
    s_lshl_b32 s74, s89, 1
    s_lshr_b32 s76, s58, 1
    s_add_u32 s74, s74, s76
    s_mul_i32 s74, s74, 34816
    s_and_b32 s76, s58, 1
    s_lshl_b32 s76, s76, 12
    s_add_u32 s74, s74, s76
    s_add_u32 s74, s74, 10485760
    s_add_u32 s95, s74, 0
    s_add_u32 m0, s75, 0
    s_nop 0
    buffer_load_dwordx4 v10, s[36:39], s95 offen sc0 sc1 lds
    s_add_u32 s95, s74, 1024
    s_add_u32 m0, s75, 1024
    s_nop 0
    buffer_load_dwordx4 v10, s[36:39], s95 offen sc0 sc1 lds
    s_add_u32 s95, s74, 2048
    s_add_u32 m0, s75, 2048
    s_nop 0
    buffer_load_dwordx4 v10, s[36:39], s95 offen sc0 sc1 lds
    s_add_u32 s95, s74, 3072
    s_add_u32 m0, s75, 3072
    s_nop 0
    buffer_load_dwordx4 v10, s[36:39], s95 offen sc0 sc1 lds
    s_add_u32 s95, s74, 8192
    s_add_u32 m0, s75, 8192
    s_nop 0
    buffer_load_dwordx4 v10, s[36:39], s95 offen sc0 sc1 lds
    s_add_u32 s95, s74, 9216
    s_add_u32 m0, s75, 9216
    s_nop 0
    buffer_load_dwordx4 v10, s[36:39], s95 offen sc0 sc1 lds
    s_add_u32 s95, s74, 10240
    s_add_u32 m0, s75, 10240
    s_nop 0
    buffer_load_dwordx4 v10, s[36:39], s95 offen sc0 sc1 lds
    s_add_u32 s95, s74, 11264
    s_add_u32 m0, s75, 11264
    s_nop 0
    buffer_load_dwordx4 v10, s[36:39], s95 offen sc0 sc1 lds
    s_add_u32 s95, s74, 16384
    s_add_u32 m0, s75, 16384
    s_nop 0
    buffer_load_dwordx4 v10, s[36:39], s95 offen sc0 sc1 lds
    s_add_u32 s95, s74, 17408
    s_add_u32 m0, s75, 17408
    s_nop 0
    buffer_load_dwordx4 v10, s[36:39], s95 offen sc0 sc1 lds
    s_add_u32 s95, s74, 18432
    s_add_u32 m0, s75, 18432
    s_nop 0
    buffer_load_dwordx4 v10, s[36:39], s95 offen sc0 sc1 lds
    s_add_u32 s95, s74, 19456
    s_add_u32 m0, s75, 19456
    s_nop 0
    buffer_load_dwordx4 v10, s[36:39], s95 offen sc0 sc1 lds
    s_add_u32 s95, s74, 24576
    s_add_u32 m0, s75, 24576
    s_nop 0
    buffer_load_dwordx4 v10, s[36:39], s95 offen sc0 sc1 lds
    s_add_u32 s95, s74, 25600
    s_add_u32 m0, s75, 25600
    s_nop 0
    buffer_load_dwordx4 v10, s[36:39], s95 offen sc0 sc1 lds
    s_add_u32 s95, s74, 26624
    s_add_u32 m0, s75, 26624
    s_nop 0
    buffer_load_dwordx4 v10, s[36:39], s95 offen sc0 sc1 lds
    s_add_u32 s95, s74, 27648
    s_add_u32 m0, s75, 27648
    s_nop 0
    buffer_load_dwordx4 v10, s[36:39], s95 offen sc0 sc1 lds
    s_or_b32 s74, s2, s58
    s_cmp_lg_u32 s74, 0
    s_cbranch_scc1 L_nobump
    s_mov_b32 s75, 7340032
    v_mov_b32 v28, s80
    v_mov_b32 v29, s75
    s_mov_b64 exec, 1
    buffer_store_dword v28, v29, s[36:39], 0 offen sc0 sc1
    s_mov_b64 exec, -1
L_nobump:
    s_waitcnt vmcnt(8)
    s_barrier
    ds_read_b128 v[32:35], v11 offset:0
    ds_read_b128 v[36:39], v11 offset:1024
    ds_read_b128 v[40:43], v11 offset:2048
    ds_read_b128 v[44:47], v11 offset:3072
    ds_read_b128 v[48:51], v11 offset:4096
    ds_read_b128 v[52:55], v11 offset:5120
    ds_read_b128 v[56:59], v11 offset:6144
    s_waitcnt lgkmcnt(6)
    v_mfma_f32_32x32x16_bf16 v[16:31], a[0:3], v[32:35], 0
    ds_read_b128 v[60:63], v11 offset:7168
    s_waitcnt lgkmcnt(6)
    v_mfma_f32_32x32x16_bf16 v[16:31], a[4:7], v[36:39], v[16:31]
    ds_read_b128 v[32:35], v11 offset:8192
    s_waitcnt lgkmcnt(6)
    v_mfma_f32_32x32x16_bf16 v[16:31], a[8:11], v[40:43], v[16:31]
    ds_read_b128 v[36:39], v11 offset:9216
    s_waitcnt lgkmcnt(6)
    v_mfma_f32_32x32x16_bf16 v[16:31], a[12:15], v[44:47], v[16:31]
    ds_read_b128 v[40:43], v11 offset:10240
    s_waitcnt lgkmcnt(6)
    v_mfma_f32_32x32x16_bf16 v[16:31], a[16:19], v[48:51], v[16:31]
    ds_read_b128 v[44:47], v11 offset:11264
    s_waitcnt lgkmcnt(6)
    v_mfma_f32_32x32x16_bf16 v[16:31], a[20:23], v[52:55], v[16:31]
    ds_read_b128 v[48:51], v11 offset:12288
    s_waitcnt lgkmcnt(6)
    v_mfma_f32_32x32x16_bf16 v[16:31], a[24:27], v[56:59], v[16:31]
    ds_read_b128 v[52:55], v11 offset:13312
    s_waitcnt lgkmcnt(6)
    v_mfma_f32_32x32x16_bf16 v[16:31], a[28:31], v[60:63], v[16:31]
    ds_read_b128 v[56:59], v11 offset:14336
    s_waitcnt lgkmcnt(6)
    v_mfma_f32_32x32x16_bf16 v[16:31], a[32:35], v[32:35], v[16:31]
    ds_read_b128 v[60:63], v11 offset:15360
    s_waitcnt lgkmcnt(6)
    v_mfma_f32_32x32x16_bf16 v[16:31], a[36:39], v[36:39], v[16:31]
    s_waitcnt lgkmcnt(5)
    v_mfma_f32_32x32x16_bf16 v[16:31], a[40:43], v[40:43], v[16:31]
    s_waitcnt lgkmcnt(4)
    v_mfma_f32_32x32x16_bf16 v[16:31], a[44:47], v[44:47], v[16:31]
    s_waitcnt lgkmcnt(3)
    v_mfma_f32_32x32x16_bf16 v[16:31], a[48:51], v[48:51], v[16:31]
    s_waitcnt lgkmcnt(2)
    v_mfma_f32_32x32x16_bf16 v[16:31], a[52:55], v[52:55], v[16:31]
    s_waitcnt lgkmcnt(1)
    v_mfma_f32_32x32x16_bf16 v[16:31], a[56:59], v[56:59], v[16:31]
    s_waitcnt lgkmcnt(0)
    v_mfma_f32_32x32x16_bf16 v[16:31], a[60:63], v[60:63], v[16:31]
    s_waitcnt vmcnt(0)
    s_barrier
    ds_read_b128 v[32:35], v11 offset:16384
    ds_read_b128 v[36:39], v11 offset:17408
    ds_read_b128 v[40:43], v11 offset:18432
    ds_read_b128 v[44:47], v11 offset:19456
    ds_read_b128 v[48:51], v11 offset:20480
    ds_read_b128 v[52:55], v11 offset:21504
    ds_read_b128 v[56:59], v11 offset:22528
    s_waitcnt lgkmcnt(6)
    v_mfma_f32_32x32x16_bf16 v[16:31], a[64:67], v[32:35], v[16:31]
    ds_read_b128 v[60:63], v11 offset:23552
    s_waitcnt lgkmcnt(6)
    v_mfma_f32_32x32x16_bf16 v[16:31], a[68:71], v[36:39], v[16:31]
    ds_read_b128 v[32:35], v11 offset:24576
    s_waitcnt lgkmcnt(6)
    v_mfma_f32_32x32x16_bf16 v[16:31], a[72:75], v[40:43], v[16:31]
    ds_read_b128 v[36:39], v11 offset:25600
    s_waitcnt lgkmcnt(6)
    v_mfma_f32_32x32x16_bf16 v[16:31], a[76:79], v[44:47], v[16:31]
    ds_read_b128 v[40:43], v11 offset:26624
    s_waitcnt lgkmcnt(6)
    v_mfma_f32_32x32x16_bf16 v[16:31], a[80:83], v[48:51], v[16:31]
    ds_read_b128 v[44:47], v11 offset:27648
    s_waitcnt lgkmcnt(6)
    v_mfma_f32_32x32x16_bf16 v[16:31], a[84:87], v[52:55], v[16:31]
    ds_read_b128 v[48:51], v11 offset:28672
    s_waitcnt lgkmcnt(6)
    v_mfma_f32_32x32x16_bf16 v[16:31], a[88:91], v[56:59], v[16:31]
    ds_read_b128 v[52:55], v11 offset:29696
    s_waitcnt lgkmcnt(6)
    v_mfma_f32_32x32x16_bf16 v[16:31], a[92:95], v[60:63], v[16:31]
    ds_read_b128 v[56:59], v11 offset:30720
    s_waitcnt lgkmcnt(6)
    v_mfma_f32_32x32x16_bf16 v[16:31], a[96:99], v[32:35], v[16:31]
    ds_read_b128 v[60:63], v11 offset:31744
    s_waitcnt lgkmcnt(6)
    v_mfma_f32_32x32x16_bf16 v[16:31], a[100:103], v[36:39], v[16:31]
    s_waitcnt lgkmcnt(5)
    v_mfma_f32_32x32x16_bf16 v[16:31], a[104:107], v[40:43], v[16:31]
    s_waitcnt lgkmcnt(4)
    v_mfma_f32_32x32x16_bf16 v[16:31], a[108:111], v[44:47], v[16:31]
    s_waitcnt lgkmcnt(3)
    v_mfma_f32_32x32x16_bf16 v[16:31], a[112:115], v[48:51], v[16:31]
    s_waitcnt lgkmcnt(2)
    v_mfma_f32_32x32x16_bf16 v[16:31], a[116:119], v[52:55], v[16:31]
    s_waitcnt lgkmcnt(1)
    v_mfma_f32_32x32x16_bf16 v[16:31], a[120:123], v[56:59], v[16:31]
    s_waitcnt lgkmcnt(0)
    v_mfma_f32_32x32x16_bf16 v[16:31], a[124:127], v[60:63], v[16:31]
    s_nop 11
    v_cvt_pk_bf16_f32 v32, v16, v17
    s_nop 0
    v_cvt_pk_bf16_f32 v33, v18, v19
    v_cvt_pk_bf16_f32 v34, v20, v21
    v_cvt_pk_bf16_f32 v35, v22, v23
    v_cvt_pk_bf16_f32 v36, v24, v25
    v_cvt_pk_bf16_f32 v37, v26, v27
    v_cvt_pk_bf16_f32 v38, v28, v29
    v_cvt_pk_bf16_f32 v39, v30, v31
    v_permlane32_swap_b32 v32, v34
    v_permlane32_swap_b32 v33, v35
    v_permlane32_swap_b32 v36, v38
    v_permlane32_swap_b32 v37, v39
    buffer_store_dwordx4 v[32:35], v2, s[52:55], s59 offen nt
    buffer_store_dwordx4 v[36:39], v2, s[52:55], s59 offen offset:32 nt
L_a_fin:
    s_waitcnt vmcnt(0)
    s_endpgm
.p2align 6
L_B:
    s_setprio 3
    s_load_dwordx8 s[12:19], s[0:1], 32
    s_load_dwordx4 s[20:23], s[0:1], 64
    s_load_dwordx4 s[4:7], s[0:1], 80
    s_sub_u32 s3, s2, 256
    s_min_u32 s88, s3, 223
    s_and_b32 s74, s88, 7
    s_lshl_b32 s74, s74, 2
    s_bfe_u32 s75, s88, 0x20003
    s_add_u32 s89, s74, s75
    s_lshr_b32 s90, s88, 5
    s_lshr_b32 s74, s58, 1
    s_lshl_b32 s75, s88, 1
    s_add_u32 s94, s75, s74
    s_mul_i32 s92, s58, 8704
    v_lshlrev_b32_e64 v10, 4, v0
    s_mov_b32 s78, 0x3fb8aa3b
    s_mov_b32 s79, 0x3fb8aa3b
    s_mov_b32 s93, 0xffff0000
    s_mov_b32 s84, 0
    s_mov_b32 s85, -1
    s_lshl_b32 s76, s94, 9
    s_and_b32 s77, s58, 1
    s_lshl_b32 s77, s77, 8
    s_add_u32 s76, s76, s77
    v_lshl_add_u32 v14, v0, 2, s76
    v_lshrrev_b32_e64 v11, 3, v0
    v_mul_u32_u24 v11, 896, v11
    v_and_b32 v12, 7, v0
    v_lshl_add_u32 v11, v12, 4, v11
    s_lshl_b32 s74, s90, 7
    s_add_u32 s74, s74, 7341056
    v_mov_b32 v24, s74
    s_waitcnt lgkmcnt(0)
    global_load_dword v32, v14, s[14:15]
    global_load_dword v33, v14, s[16:17]
    global_load_dword v34, v14, s[18:19]
    global_load_dword v35, v14, s[20:21]
    s_lshl_b32 s76, s88, 2
    s_add_u32 s22, s22, s76
    s_addc_u32 s23, s23, 0
    s_load_dword s91, s[22:23], 0
    s_mov_b32 s36, s26
    s_and_b32 s37, s27, 0xffff
    s_mov_b32 s38, 268435456
    s_mov_b32 s39, 0x20000
    s_mov_b32 s40, s12
    s_and_b32 s41, s13, 0xffff
    s_mov_b32 s42, 1835008
    s_mov_b32 s43, 0x20000
    s_mov_b32 s48, s4
    s_and_b32 s49, s5, 0xffff
    s_mov_b32 s50, 896
    s_mov_b32 s51, 0x20000
    s_mov_b32 s52, s6
    s_and_b32 s53, s7, 0xffff
    s_mov_b32 s54, 3670016
    s_mov_b32 s55, 0x20000
    buffer_load_dword v30, v24, s[36:39], 0 offen sc0 sc1
    s_lshr_b32 s74, s58, 1
    s_lshl_b32 s74, s74, 4
    s_waitcnt lgkmcnt(0)
    s_lshr_b32 s91, s91, s74
    s_lshl_b32 s91, s91, 16
    v_mov_b32 v36, s91
    v_mul_f32 v36, s78, v36
    v_exp_f32 v36, v36
    v_and_b32 v11, 15, v0
    v_mul_u32_u24 v11, 272, v11
    v_lshrrev_b32 v12, 4, v0
    v_lshl_add_u32 v11, v12, 4, v11
    v_add_u32 v9, s92, v11
    v_cvt_pk_bf16_f32 v36, v36, v36
    v_lshlrev_b32 v36, 16, v36
    s_mov_b32 m0, s92
    s_setprio 0
    s_waitcnt vmcnt(4)
    v_lshlrev_b32 v37, 16, v32
    s_waitcnt vmcnt(3)
    v_lshlrev_b32 v38, 16, v33
    s_waitcnt vmcnt(2)
    v_lshlrev_b32 v50, 16, v34
    s_waitcnt vmcnt(1)
    v_lshlrev_b32 v51, 16, v35
    v_mul_f32 v37, s78, v37
    v_exp_f32 v37, v37
    v_mul_f32 v38, v36, v38
    v_cvt_pk_bf16_f32 v37, v37, v37
    v_mul_f32 v38, 0.15915494, v38
    v_lshlrev_b32 v37, 16, v37
    v_mul_f32 v37, v36, v37
    v_mul_f32 v50, v36, v50
    v_mul_f32 v51, v36, v51
    v_mul_f32 v37, s78, v37
    v_pk_add_f32 v[50:51], v[50:51], v[50:51]
    v_exp_f32 v116, -v37
    v_fract_f32 v117, v38
    v_mul_f32 v118, 0x41000000, v37
    v_mul_f32 v119, 0x41000000, v38
    v_exp_f32 v118, -v118
    v_fract_f32 v119, v119
    v_mul_f32 v120, 0x43000000, v37
    v_mul_f32 v121, 0x43000000, v38
    v_exp_f32 v120, -v120
    v_fract_f32 v121, v121
    v_cos_f32 v40, v117
    v_sin_f32 v41, v117
    v_cos_f32 v42, v119
    v_sin_f32 v43, v119
    v_cos_f32 v44, v121
    v_sin_f32_e64 v45, v121
    v_pk_mul_f32 v[40:41], v[40:41], v[116:117] op_sel_hi:[1,0]
    v_pk_mul_f32 v[42:43], v[42:43], v[118:119] op_sel_hi:[1,0]
    v_pk_mul_f32 v[44:45], v[44:45], v[120:121] op_sel_hi:[1,0]
    v_pk_mul_f32 v[46:47], v[42:43], v[42:43] op_sel_hi:[1,0]
    v_pk_fma_f32 v[46:47], v[42:43], v[42:43], v[46:47] op_sel:[1,1,0] op_sel_hi:[0,1,1] neg_lo:[1,0,0]
    v_pk_mul_f32 v[48:49], v[44:45], v[44:45] op_sel_hi:[1,0]
    v_pk_fma_f32 v[48:49], v[44:45], v[44:45], v[48:49] op_sel:[1,1,0] op_sel_hi:[0,1,1] neg_lo:[1,0,0]
    v_mov_b32 v124, 0x3f80
    ds_write_addtid_b32 v124 offset:0
    v_cvt_pk_bf16_f32 v125, v42, -v43
    ds_write_addtid_b32 v125 offset:272
    v_cvt_pk_bf16_f32 v126, v46, -v47
    ds_write_addtid_b32 v126 offset:544
    v_pk_mul_f32 v[118:119], v[42:43], v[46:47] op_sel_hi:[1,0]
    v_pk_fma_f32 v[118:119], v[42:43], v[46:47], v[118:119] op_sel:[1,1,0] op_sel_hi:[0,1,1] neg_lo:[1,0,0]
    v_cvt_pk_bf16_f32 v127, v118, -v119
    ds_write_addtid_b32 v127 offset:816
    v_pk_mul_f32 v[116:117], v[46:47], v[46:47] op_sel_hi:[1,0]
    v_pk_fma_f32 v[116:117], v[46:47], v[46:47], v[116:117] op_sel:[1,1,0] op_sel_hi:[0,1,1] neg_lo:[1,0,0]
    v_cvt_pk_bf16_f32 v124, v116, -v117
    ds_write_addtid_b32 v124 offset:1088
    v_pk_mul_f32 v[122:123], v[118:119], v[46:47] op_sel_hi:[1,0]
    v_pk_fma_f32 v[122:123], v[118:119], v[46:47], v[122:123] op_sel:[1,1,0] op_sel_hi:[0,1,1] neg_lo:[1,0,0]
    v_cvt_pk_bf16_f32 v125, v122, -v123
    ds_write_addtid_b32 v125 offset:1360
    v_pk_mul_f32 v[120:121], v[116:117], v[46:47] op_sel_hi:[1,0]
    v_pk_fma_f32 v[120:121], v[116:117], v[46:47], v[120:121] op_sel:[1,1,0] op_sel_hi:[0,1,1] neg_lo:[1,0,0]
    v_cvt_pk_bf16_f32 v126, v120, -v121
    ds_write_addtid_b32 v126 offset:1632
    v_pk_mul_f32 v[118:119], v[122:123], v[46:47] op_sel_hi:[1,0]
    v_pk_fma_f32 v[118:119], v[122:123], v[46:47], v[118:119] op_sel:[1,1,0] op_sel_hi:[0,1,1] neg_lo:[1,0,0]
    v_cvt_pk_bf16_f32 v127, v118, -v119
    ds_write_addtid_b32 v127 offset:1904
    v_pk_mul_f32 v[116:117], v[120:121], v[46:47] op_sel_hi:[1,0]
    v_pk_fma_f32 v[116:117], v[120:121], v[46:47], v[116:117] op_sel:[1,1,0] op_sel_hi:[0,1,1] neg_lo:[1,0,0]
    v_cvt_pk_bf16_f32 v124, v116, -v117
    ds_write_addtid_b32 v124 offset:2176
    v_pk_mul_f32 v[122:123], v[118:119], v[46:47] op_sel_hi:[1,0]
    v_pk_fma_f32 v[122:123], v[118:119], v[46:47], v[122:123] op_sel:[1,1,0] op_sel_hi:[0,1,1] neg_lo:[1,0,0]
    v_cvt_pk_bf16_f32 v125, v122, -v123
    ds_write_addtid_b32 v125 offset:2448
    v_pk_mul_f32 v[120:121], v[116:117], v[46:47] op_sel_hi:[1,0]
    v_pk_fma_f32 v[120:121], v[116:117], v[46:47], v[120:121] op_sel:[1,1,0] op_sel_hi:[0,1,1] neg_lo:[1,0,0]
    v_cvt_pk_bf16_f32 v126, v120, -v121
    ds_write_addtid_b32 v126 offset:2720
    v_pk_mul_f32 v[118:119], v[122:123], v[46:47] op_sel_hi:[1,0]
    v_pk_fma_f32 v[118:119], v[122:123], v[46:47], v[118:119] op_sel:[1,1,0] op_sel_hi:[0,1,1] neg_lo:[1,0,0]
    v_cvt_pk_bf16_f32 v127, v118, -v119
    ds_write_addtid_b32 v127 offset:2992
    v_pk_mul_f32 v[116:117], v[120:121], v[46:47] op_sel_hi:[1,0]
    v_pk_fma_f32 v[116:117], v[120:121], v[46:47], v[116:117] op_sel:[1,1,0] op_sel_hi:[0,1,1] neg_lo:[1,0,0]
    v_cvt_pk_bf16_f32 v124, v116, -v117
    ds_write_addtid_b32 v124 offset:3264
    v_pk_mul_f32 v[122:123], v[118:119], v[46:47] op_sel_hi:[1,0]
    v_pk_fma_f32 v[122:123], v[118:119], v[46:47], v[122:123] op_sel:[1,1,0] op_sel_hi:[0,1,1] neg_lo:[1,0,0]
    v_cvt_pk_bf16_f32 v125, v122, -v123
    ds_write_addtid_b32 v125 offset:3536
    v_pk_mul_f32 v[120:121], v[116:117], v[46:47] op_sel_hi:[1,0]
    v_pk_fma_f32 v[120:121], v[116:117], v[46:47], v[120:121] op_sel:[1,1,0] op_sel_hi:[0,1,1] neg_lo:[1,0,0]
    v_cvt_pk_bf16_f32 v126, v120, -v121
    ds_write_addtid_b32 v126 offset:3808
    v_pk_mul_f32 v[118:119], v[122:123], v[46:47] op_sel_hi:[1,0]
    v_pk_fma_f32 v[118:119], v[122:123], v[46:47], v[118:119] op_sel:[1,1,0] op_sel_hi:[0,1,1] neg_lo:[1,0,0]
    v_cvt_pk_bf16_f32 v127, v118, -v119
    ds_write_addtid_b32 v127 offset:4080
    v_mov_b32 v52, v50
    v_mov_b32 v53, v51
    v_cvt_pk_bf16_f32 v124, v52, v53
    ds_write_addtid_b32 v124 offset:4352
    v_pk_mul_f32 v[54:55], v[52:53], v[40:41] op_sel_hi:[1,0]
    v_pk_fma_f32 v[54:55], v[52:53], v[40:41], v[54:55] op_sel:[1,1,0] op_sel_hi:[0,1,1] neg_lo:[1,0,0]
    v_cvt_pk_bf16_f32 v125, v54, v55
    ds_write_addtid_b32 v125 offset:4624
    v_pk_mul_f32 v[56:57], v[54:55], v[40:41] op_sel_hi:[1,0]
    v_pk_fma_f32 v[56:57], v[54:55], v[40:41], v[56:57] op_sel:[1,1,0] op_sel_hi:[0,1,1] neg_lo:[1,0,0]
    v_cvt_pk_bf16_f32 v126, v56, v57
    ds_write_addtid_b32 v126 offset:4896
    v_pk_mul_f32 v[58:59], v[56:57], v[40:41] op_sel_hi:[1,0]
    v_pk_fma_f32 v[58:59], v[56:57], v[40:41], v[58:59] op_sel:[1,1,0] op_sel_hi:[0,1,1] neg_lo:[1,0,0]
    v_cvt_pk_bf16_f32 v127, v58, v59
    ds_write_addtid_b32 v127 offset:5168
    v_pk_mul_f32 v[60:61], v[58:59], v[40:41] op_sel_hi:[1,0]
    v_pk_fma_f32 v[60:61], v[58:59], v[40:41], v[60:61] op_sel:[1,1,0] op_sel_hi:[0,1,1] neg_lo:[1,0,0]
    v_cvt_pk_bf16_f32 v124, v60, v61
    ds_write_addtid_b32 v124 offset:5440
    v_pk_mul_f32 v[62:63], v[60:61], v[40:41] op_sel_hi:[1,0]
    v_pk_fma_f32 v[62:63], v[60:61], v[40:41], v[62:63] op_sel:[1,1,0] op_sel_hi:[0,1,1] neg_lo:[1,0,0]
    v_cvt_pk_bf16_f32 v125, v62, v63
    ds_write_addtid_b32 v125 offset:5712
    v_pk_mul_f32 v[64:65], v[62:63], v[40:41] op_sel_hi:[1,0]
    v_pk_fma_f32 v[64:65], v[62:63], v[40:41], v[64:65] op_sel:[1,1,0] op_sel_hi:[0,1,1] neg_lo:[1,0,0]
    v_cvt_pk_bf16_f32 v126, v64, v65
    ds_write_addtid_b32 v126 offset:5984
    v_pk_mul_f32 v[66:67], v[64:65], v[40:41] op_sel_hi:[1,0]
    v_pk_fma_f32 v[66:67], v[64:65], v[40:41], v[66:67] op_sel:[1,1,0] op_sel_hi:[0,1,1] neg_lo:[1,0,0]
    v_cvt_pk_bf16_f32 v127, v66, v67
    ds_write_addtid_b32 v127 offset:6256
    v_pk_mul_f32 v[68:69], v[52:53], v[44:45] op_sel_hi:[1,0]
    v_pk_fma_f32 v[68:69], v[52:53], v[44:45], v[68:69] op_sel:[1,1,0] op_sel_hi:[0,1,1] neg_lo:[1,0,0]
    v_cvt_pk_bf16_f32 v124, v68, v69
    ds_write_addtid_b32 v124 offset:6528
    v_pk_mul_f32 v[70:71], v[54:55], v[44:45] op_sel_hi:[1,0]
    v_pk_fma_f32 v[70:71], v[54:55], v[44:45], v[70:71] op_sel:[1,1,0] op_sel_hi:[0,1,1] neg_lo:[1,0,0]
    v_cvt_pk_bf16_f32 v125, v70, v71
    ds_write_addtid_b32 v125 offset:6800
    v_pk_mul_f32 v[72:73], v[56:57], v[44:45] op_sel_hi:[1,0]
    v_pk_fma_f32 v[72:73], v[56:57], v[44:45], v[72:73] op_sel:[1,1,0] op_sel_hi:[0,1,1] neg_lo:[1,0,0]
    v_cvt_pk_bf16_f32 v126, v72, v73
    ds_write_addtid_b32 v126 offset:7072
    v_pk_mul_f32 v[74:75], v[58:59], v[44:45] op_sel_hi:[1,0]
    v_pk_fma_f32 v[74:75], v[58:59], v[44:45], v[74:75] op_sel:[1,1,0] op_sel_hi:[0,1,1] neg_lo:[1,0,0]
    v_cvt_pk_bf16_f32 v127, v74, v75
    ds_write_addtid_b32 v127 offset:7344
    v_pk_mul_f32 v[76:77], v[60:61], v[44:45] op_sel_hi:[1,0]
    v_pk_fma_f32 v[76:77], v[60:61], v[44:45], v[76:77] op_sel:[1,1,0] op_sel_hi:[0,1,1] neg_lo:[1,0,0]
    v_cvt_pk_bf16_f32 v124, v76, v77
    ds_write_addtid_b32 v124 offset:7616
    v_pk_mul_f32 v[78:79], v[62:63], v[44:45] op_sel_hi:[1,0]
    v_pk_fma_f32 v[78:79], v[62:63], v[44:45], v[78:79] op_sel:[1,1,0] op_sel_hi:[0,1,1] neg_lo:[1,0,0]
    v_lshrrev_b32 v11, 3, v0
    v_mul_u32_u24 v11, 896, v11
    v_and_b32 v12, 7, v0
    v_lshl_add_u32 v11, v12, 4, v11
    s_lshl_b32 s74, s89, 6
    s_lshl_b32 s75, s58, 4
    s_add_u32 s74, s74, s75
    s_mul_i32 s74, s74, 896
    s_lshl_b32 s75, s90, 7
    s_add_u32 s74, s74, s75
    s_lshl_b32 s76, s58, 11
    s_add_u32 s76, s76, 40960
    s_add_u32 m0, s76, 0
    s_nop 0
    buffer_load_dwordx4 v11, s[40:43], s74 offen lds
    s_add_u32 s74, s74, 7168
    s_add_u32 m0, s76, 1024
    s_nop 0
    buffer_load_dwordx4 v11, s[40:43], s74 offen lds
    s_mov_b32 m0, s92
    v_cvt_pk_bf16_f32 v125, v78, v79
    ds_write_addtid_b32 v125 offset:7888
    v_pk_mul_f32 v[80:81], v[64:65], v[44:45] op_sel_hi:[1,0]
    v_pk_fma_f32 v[80:81], v[64:65], v[44:45], v[80:81] op_sel:[1,1,0] op_sel_hi:[0,1,1] neg_lo:[1,0,0]
    v_cvt_pk_bf16_f32 v126, v80, v81
    ds_write_addtid_b32 v126 offset:8160
    v_pk_mul_f32 v[82:83], v[66:67], v[44:45] op_sel_hi:[1,0]
    v_pk_fma_f32 v[82:83], v[66:67], v[44:45], v[82:83] op_sel:[1,1,0] op_sel_hi:[0,1,1] neg_lo:[1,0,0]
    v_cvt_pk_bf16_f32 v127, v82, v83
    ds_write_addtid_b32 v127 offset:8432
    ds_read_b128 a[16:19], v9 offset:0
    ds_read_b128 a[20:23], v9 offset:64
    ds_read_b128 a[24:27], v9 offset:128
    ds_read_b128 a[28:31], v9 offset:192
    ds_read_b128 a[32:35], v9 offset:4352
    ds_read_b128 a[36:39], v9 offset:4416
    ds_read_b128 a[40:43], v9 offset:4480
    ds_read_b128 a[44:47], v9 offset:4544
    v_pk_mul_f32 v[84:85], v[68:69], v[44:45] op_sel_hi:[1,0]
    v_pk_fma_f32 v[84:85], v[68:69], v[44:45], v[84:85] op_sel:[1,1,0] op_sel_hi:[0,1,1] neg_lo:[1,0,0]
    v_pk_mul_f32 v[86:87], v[72:73], v[44:45] op_sel_hi:[1,0]
    v_pk_fma_f32 v[86:87], v[72:73], v[44:45], v[86:87] op_sel:[1,1,0] op_sel_hi:[0,1,1] neg_lo:[1,0,0]
    v_pk_mul_f32 v[88:89], v[76:77], v[44:45] op_sel_hi:[1,0]
    v_pk_fma_f32 v[88:89], v[76:77], v[44:45], v[88:89] op_sel:[1,1,0] op_sel_hi:[0,1,1] neg_lo:[1,0,0]
    v_pk_mul_f32 v[90:91], v[80:81], v[44:45] op_sel_hi:[1,0]
    v_pk_fma_f32 v[90:91], v[80:81], v[44:45], v[90:91] op_sel:[1,1,0] op_sel_hi:[0,1,1] neg_lo:[1,0,0]
    v_pk_mul_f32 v[92:93], v[84:85], v[44:45] op_sel_hi:[1,0]
    v_pk_fma_f32 v[92:93], v[84:85], v[44:45], v[92:93] op_sel:[1,1,0] op_sel_hi:[0,1,1] neg_lo:[1,0,0]
    v_pk_mul_f32 v[94:95], v[86:87], v[44:45] op_sel_hi:[1,0]
    v_pk_fma_f32 v[94:95], v[86:87], v[44:45], v[94:95] op_sel:[1,1,0] op_sel_hi:[0,1,1] neg_lo:[1,0,0]
    v_pk_mul_f32 v[96:97], v[88:89], v[44:45] op_sel_hi:[1,0]
    v_pk_fma_f32 v[96:97], v[88:89], v[44:45], v[96:97] op_sel:[1,1,0] op_sel_hi:[0,1,1] neg_lo:[1,0,0]
    v_pk_mul_f32 v[98:99], v[90:91], v[44:45] op_sel_hi:[1,0]
    v_pk_fma_f32 v[98:99], v[90:91], v[44:45], v[98:99] op_sel:[1,1,0] op_sel_hi:[0,1,1] neg_lo:[1,0,0]
    v_pk_mul_f32 v[100:101], v[92:93], v[44:45] op_sel_hi:[1,0]
    v_pk_fma_f32 v[100:101], v[92:93], v[44:45], v[100:101] op_sel:[1,1,0] op_sel_hi:[0,1,1] neg_lo:[1,0,0]
    v_pk_mul_f32 v[102:103], v[96:97], v[44:45] op_sel_hi:[1,0]
    v_pk_fma_f32 v[102:103], v[96:97], v[44:45], v[102:103] op_sel:[1,1,0] op_sel_hi:[0,1,1] neg_lo:[1,0,0]
    v_pk_mul_f32 v[104:105], v[100:101], v[44:45] op_sel_hi:[1,0]
    v_pk_fma_f32 v[104:105], v[100:101], v[44:45], v[104:105] op_sel:[1,1,0] op_sel_hi:[0,1,1] neg_lo:[1,0,0]
    v_pk_mul_f32 v[106:107], v[102:103], v[44:45] op_sel_hi:[1,0]
    v_pk_fma_f32 v[106:107], v[102:103], v[44:45], v[106:107] op_sel:[1,1,0] op_sel_hi:[0,1,1] neg_lo:[1,0,0]
    v_pk_mul_f32 v[108:109], v[104:105], v[44:45] op_sel_hi:[1,0]
    v_pk_fma_f32 v[108:109], v[104:105], v[44:45], v[108:109] op_sel:[1,1,0] op_sel_hi:[0,1,1] neg_lo:[1,0,0]
    v_pk_mul_f32 v[110:111], v[106:107], v[44:45] op_sel_hi:[1,0]
    v_pk_fma_f32 v[110:111], v[106:107], v[44:45], v[110:111] op_sel:[1,1,0] op_sel_hi:[0,1,1] neg_lo:[1,0,0]
    v_pk_mul_f32 v[112:113], v[108:109], v[44:45] op_sel_hi:[1,0]
    v_pk_fma_f32 v[112:113], v[108:109], v[44:45], v[112:113] op_sel:[1,1,0] op_sel_hi:[0,1,1] neg_lo:[1,0,0]
    v_pk_mul_f32 v[114:115], v[110:111], v[44:45] op_sel_hi:[1,0]
    v_pk_fma_f32 v[114:115], v[110:111], v[44:45], v[114:115] op_sel:[1,1,0] op_sel_hi:[0,1,1] neg_lo:[1,0,0]
    s_waitcnt lgkmcnt(3)
    v_mfma_f32_16x16x32_bf16 a[0:3], a[32:35], a[16:19], 0
    s_waitcnt lgkmcnt(2)
    v_mfma_f32_16x16x32_bf16 a[0:3], a[36:39], a[20:23], a[0:3]
    s_waitcnt lgkmcnt(1)
    v_mfma_f32_16x16x32_bf16 a[0:3], a[40:43], a[24:27], a[0:3]
    s_waitcnt lgkmcnt(0)
    v_mfma_f32_16x16x32_bf16 a[0:3], a[44:47], a[28:31], a[0:3]
    v_cvt_pk_bf16_f32 v124, v84, v85
    ds_write_addtid_b32 v124 offset:4352
    v_cvt_pk_bf16_f32 v125, v86, v87
    ds_write_addtid_b32 v125 offset:4624
    v_cvt_pk_bf16_f32 v126, v88, v89
    ds_write_addtid_b32 v126 offset:4896
    v_cvt_pk_bf16_f32 v127, v90, v91
    ds_write_addtid_b32 v127 offset:5168
    v_cvt_pk_bf16_f32 v124, v92, v93
    ds_write_addtid_b32 v124 offset:5440
    v_cvt_pk_bf16_f32 v125, v94, v95
    ds_write_addtid_b32 v125 offset:5712
    v_cvt_pk_bf16_f32 v126, v96, v97
    ds_write_addtid_b32 v126 offset:5984
    v_cvt_pk_bf16_f32 v127, v98, v99
    ds_write_addtid_b32 v127 offset:6256
    v_cvt_pk_bf16_f32 v124, v100, v101
    ds_write_addtid_b32 v124 offset:6528
    v_cvt_pk_bf16_f32 v125, v102, v103
    ds_write_addtid_b32 v125 offset:6800
    v_cvt_pk_bf16_f32 v126, v104, v105
    ds_write_addtid_b32 v126 offset:7072
    v_cvt_pk_bf16_f32 v127, v106, v107
    ds_write_addtid_b32 v127 offset:7344
    v_cvt_pk_bf16_f32 v124, v108, v109
    ds_write_addtid_b32 v124 offset:7616
    v_cvt_pk_bf16_f32 v125, v110, v111
    ds_write_addtid_b32 v125 offset:7888
    v_cvt_pk_bf16_f32 v126, v112, v113
    ds_write_addtid_b32 v126 offset:8160
    v_cvt_pk_bf16_f32 v127, v114, v115
    ds_write_addtid_b32 v127 offset:8432
    ds_read_b128 a[32:35], v9 offset:4352
    ds_read_b128 a[36:39], v9 offset:4416
    ds_read_b128 a[40:43], v9 offset:4480
    ds_read_b128 a[44:47], v9 offset:4544
    v_pk_mul_f32 v[52:53], v[112:113], v[44:45] op_sel_hi:[1,0]
    v_pk_fma_f32 v[52:53], v[112:113], v[44:45], v[52:53] op_sel:[1,1,0] op_sel_hi:[0,1,1] neg_lo:[1,0,0]
    v_pk_mul_f32 v[54:55], v[52:53], v[44:45] op_sel_hi:[1,0]
    v_pk_fma_f32 v[54:55], v[52:53], v[44:45], v[54:55] op_sel:[1,1,0] op_sel_hi:[0,1,1] neg_lo:[1,0,0]
    v_pk_mul_f32 v[56:57], v[52:53], v[48:49] op_sel_hi:[1,0]
    v_pk_fma_f32 v[56:57], v[52:53], v[48:49], v[56:57] op_sel:[1,1,0] op_sel_hi:[0,1,1] neg_lo:[1,0,0]
    v_pk_mul_f32 v[58:59], v[54:55], v[48:49] op_sel_hi:[1,0]
    v_pk_fma_f32 v[58:59], v[54:55], v[48:49], v[58:59] op_sel:[1,1,0] op_sel_hi:[0,1,1] neg_lo:[1,0,0]
    v_pk_mul_f32 v[60:61], v[56:57], v[48:49] op_sel_hi:[1,0]
    v_pk_fma_f32 v[60:61], v[56:57], v[48:49], v[60:61] op_sel:[1,1,0] op_sel_hi:[0,1,1] neg_lo:[1,0,0]
    v_pk_mul_f32 v[62:63], v[58:59], v[48:49] op_sel_hi:[1,0]
    v_pk_fma_f32 v[62:63], v[58:59], v[48:49], v[62:63] op_sel:[1,1,0] op_sel_hi:[0,1,1] neg_lo:[1,0,0]
    v_pk_mul_f32 v[64:65], v[60:61], v[48:49] op_sel_hi:[1,0]
    v_pk_fma_f32 v[64:65], v[60:61], v[48:49], v[64:65] op_sel:[1,1,0] op_sel_hi:[0,1,1] neg_lo:[1,0,0]
    v_pk_mul_f32 v[66:67], v[62:63], v[48:49] op_sel_hi:[1,0]
    v_pk_fma_f32 v[66:67], v[62:63], v[48:49], v[66:67] op_sel:[1,1,0] op_sel_hi:[0,1,1] neg_lo:[1,0,0]
    v_pk_mul_f32 v[68:69], v[64:65], v[48:49] op_sel_hi:[1,0]
    v_pk_fma_f32 v[68:69], v[64:65], v[48:49], v[68:69] op_sel:[1,1,0] op_sel_hi:[0,1,1] neg_lo:[1,0,0]
    s_waitcnt lgkmcnt(3)
    v_mfma_f32_16x16x32_bf16 a[4:7], a[32:35], a[16:19], 0
    s_waitcnt lgkmcnt(2)
    v_mfma_f32_16x16x32_bf16 a[4:7], a[36:39], a[20:23], a[4:7]
    s_waitcnt lgkmcnt(1)
    v_mfma_f32_16x16x32_bf16 a[4:7], a[40:43], a[24:27], a[4:7]
    s_waitcnt lgkmcnt(0)
    v_mfma_f32_16x16x32_bf16 a[4:7], a[44:47], a[28:31], a[4:7]
    v_cvt_pk_bf16_f32 v124, v52, v53
    ds_write_addtid_b32 v124 offset:4352
    v_cvt_pk_bf16_f32 v125, v54, v55
    ds_write_addtid_b32 v125 offset:4624
    v_cvt_pk_bf16_f32 v126, v56, v57
    ds_write_addtid_b32 v126 offset:4896
    v_cvt_pk_bf16_f32 v127, v58, v59
    ds_write_addtid_b32 v127 offset:5168
    v_cvt_pk_bf16_f32 v124, v60, v61
    ds_write_addtid_b32 v124 offset:5440
    v_cvt_pk_bf16_f32 v125, v62, v63
    ds_write_addtid_b32 v125 offset:5712
    v_cvt_pk_bf16_f32 v126, v64, v65
    ds_write_addtid_b32 v126 offset:5984
    v_cvt_pk_bf16_f32 v127, v66, v67
    ds_write_addtid_b32 v127 offset:6256
    v_cvt_pk_bf16_f32 v124, v68, v69
    ds_write_addtid_b32 v124 offset:6528
    ds_read_b128 a[32:35], v9 offset:4352
    ds_read_b128 a[36:39], v9 offset:4416
    ds_read_b128 a[40:43], v9 offset:4480
    ds_read_b128 a[44:47], v9 offset:4544
    s_waitcnt lgkmcnt(3)
    v_mfma_f32_16x16x32_bf16 a[8:11], a[32:35], a[16:19], 0
    s_waitcnt lgkmcnt(2)
    v_mfma_f32_16x16x32_bf16 a[8:11], a[36:39], a[20:23], a[8:11]
    s_waitcnt lgkmcnt(1)
    v_mfma_f32_16x16x32_bf16 a[8:11], a[40:43], a[24:27], a[8:11]
    s_waitcnt lgkmcnt(0)
    v_mfma_f32_16x16x32_bf16 a[8:11], a[44:47], a[28:31], a[8:11]
    v_lshrrev_b32 v11, 4, v0
    v_lshlrev_b32 v11, 3, v11
    v_bfe_u32 v12, v0, 2, 2
    v_add_u32 v11, v11, v12
    v_lshlrev_b32 v11, 7, v11
    v_and_b32 v12, 3, v0
    v_lshl_add_u32 v11, v12, 3, v11
    s_lshl_b32 s74, s58, 5
    s_add_u32 s74, s74, 40960
    v_add_u32 v11, s74, v11
    v_and_b32 v12, 15, v0
    v_lshlrev_b32 v12, 12, v12
    v_lshrrev_b32 v14, 4, v0
    v_lshl_add_u32 v12, v14, 4, v12
    s_lshl_b32 s77, s90, 2
    s_add_u32 s77, s77, s58
    s_lshl_b32 s77, s77, 16
    s_lshl_b32 s75, s89, 7
    s_add_u32 s77, s77, s75
    s_add_u32 s77, s77, 4194304
    s_waitcnt vmcnt(0)
    v_add_u32 v30, 1, v30
    s_nop 0
    v_readfirstlane_b32 s80, v30
    s_barrier
    ds_read_b64_tr_b16 v[16:17], v11 offset:0
    ds_read_b64_tr_b16 v[18:19], v11 offset:512
    ds_read_b64_tr_b16 v[20:21], v11 offset:4096
    ds_read_b64_tr_b16 v[22:23], v11 offset:4608
    s_waitcnt lgkmcnt(2)
    buffer_store_dwordx4 v[16:19], v12, s[36:39], s77 offen sc0 sc1
    s_waitcnt lgkmcnt(0)
    buffer_store_dwordx4 v[20:23], v12, s[36:39], s77 offen offset:64 sc0 sc1
    s_mov_b32 m0, s92
    v_and_b32 v37, s93, v32
    v_and_b32 v38, s93, v33
    v_and_b32 v50, s93, v34
    v_and_b32 v51, s93, v35
    v_mul_f32 v37, s78, v37
    v_exp_f32 v37, v37
    v_mul_f32 v38, v36, v38
    v_cvt_pk_bf16_f32 v37, v37, v37
    v_mul_f32 v38, 0.15915494, v38
    v_lshlrev_b32 v37, 16, v37
    v_mul_f32 v37, v36, v37
    v_mul_f32 v50, v36, v50
    v_mul_f32 v51, v36, v51
    v_mul_f32 v37, s78, v37
    v_pk_add_f32 v[50:51], v[50:51], v[50:51]
    v_exp_f32 v116, -v37
    v_fract_f32_e64 v117, v38
    v_mul_f32 v118, 0x41000000, v37
    v_mul_f32 v119, 0x41000000, v38
    v_exp_f32 v118, -v118
    v_fract_f32_e64 v119, v119
    v_mul_f32 v120, 0x43000000, v37
    v_mul_f32 v121, 0x43000000, v38
    v_exp_f32 v120, -v120
    v_fract_f32 v121, v121
    v_cos_f32 v40, v117
    v_sin_f32 v41, v117
    v_cos_f32 v42, v119
    v_sin_f32 v43, v119
    v_cos_f32 v44, v121
    v_sin_f32_e64 v45, v121
    v_pk_mul_f32 v[40:41], v[40:41], v[116:117] op_sel_hi:[1,0]
    v_pk_mul_f32 v[42:43], v[42:43], v[118:119] op_sel_hi:[1,0]
    v_pk_mul_f32 v[44:45], v[44:45], v[120:121] op_sel_hi:[1,0]
    v_pk_mul_f32 v[46:47], v[42:43], v[42:43] op_sel_hi:[1,0]
    v_pk_fma_f32 v[46:47], v[42:43], v[42:43], v[46:47] op_sel:[1,1,0] op_sel_hi:[0,1,1] neg_lo:[1,0,0]
    v_pk_mul_f32 v[48:49], v[44:45], v[44:45] op_sel_hi:[1,0]
    v_pk_fma_f32 v[48:49], v[44:45], v[44:45], v[48:49] op_sel:[1,1,0] op_sel_hi:[0,1,1] neg_lo:[1,0,0]
    v_mov_b32 v124, 0x3f80
    ds_write_addtid_b32 v124 offset:0
    v_cvt_pk_bf16_f32 v125, v42, -v43
    ds_write_addtid_b32 v125 offset:272
    v_cvt_pk_bf16_f32 v126, v46, -v47
    ds_write_addtid_b32 v126 offset:544
    v_pk_mul_f32 v[118:119], v[42:43], v[46:47] op_sel_hi:[1,0]
    v_pk_fma_f32 v[118:119], v[42:43], v[46:47], v[118:119] op_sel:[1,1,0] op_sel_hi:[0,1,1] neg_lo:[1,0,0]
    v_cvt_pk_bf16_f32 v127, v118, -v119
    ds_write_addtid_b32 v127 offset:816
    v_pk_mul_f32 v[116:117], v[46:47], v[46:47] op_sel_hi:[1,0]
    v_pk_fma_f32 v[116:117], v[46:47], v[46:47], v[116:117] op_sel:[1,1,0] op_sel_hi:[0,1,1] neg_lo:[1,0,0]
    v_cvt_pk_bf16_f32 v124, v116, -v117
    ds_write_addtid_b32 v124 offset:1088
    v_pk_mul_f32 v[122:123], v[118:119], v[46:47] op_sel_hi:[1,0]
    v_pk_fma_f32 v[122:123], v[118:119], v[46:47], v[122:123] op_sel:[1,1,0] op_sel_hi:[0,1,1] neg_lo:[1,0,0]
    v_cvt_pk_bf16_f32 v125, v122, -v123
    ds_write_addtid_b32 v125 offset:1360
    v_pk_mul_f32 v[120:121], v[116:117], v[46:47] op_sel_hi:[1,0]
    v_pk_fma_f32 v[120:121], v[116:117], v[46:47], v[120:121] op_sel:[1,1,0] op_sel_hi:[0,1,1] neg_lo:[1,0,0]
    v_cvt_pk_bf16_f32 v126, v120, -v121
    ds_write_addtid_b32 v126 offset:1632
    v_pk_mul_f32 v[118:119], v[122:123], v[46:47] op_sel_hi:[1,0]
    v_pk_fma_f32 v[118:119], v[122:123], v[46:47], v[118:119] op_sel:[1,1,0] op_sel_hi:[0,1,1] neg_lo:[1,0,0]
    v_cvt_pk_bf16_f32 v127, v118, -v119
    ds_write_addtid_b32 v127 offset:1904
    v_pk_mul_f32 v[116:117], v[120:121], v[46:47] op_sel_hi:[1,0]
    v_pk_fma_f32 v[116:117], v[120:121], v[46:47], v[116:117] op_sel:[1,1,0] op_sel_hi:[0,1,1] neg_lo:[1,0,0]
    v_cvt_pk_bf16_f32 v124, v116, -v117
    ds_write_addtid_b32 v124 offset:2176
    v_pk_mul_f32 v[122:123], v[118:119], v[46:47] op_sel_hi:[1,0]
    v_pk_fma_f32 v[122:123], v[118:119], v[46:47], v[122:123] op_sel:[1,1,0] op_sel_hi:[0,1,1] neg_lo:[1,0,0]
    v_cvt_pk_bf16_f32 v125, v122, -v123
    ds_write_addtid_b32 v125 offset:2448
    v_pk_mul_f32 v[120:121], v[116:117], v[46:47] op_sel_hi:[1,0]
    v_pk_fma_f32 v[120:121], v[116:117], v[46:47], v[120:121] op_sel:[1,1,0] op_sel_hi:[0,1,1] neg_lo:[1,0,0]
    v_cvt_pk_bf16_f32 v126, v120, -v121
    ds_write_addtid_b32 v126 offset:2720
    v_pk_mul_f32 v[118:119], v[122:123], v[46:47] op_sel_hi:[1,0]
    v_pk_fma_f32 v[118:119], v[122:123], v[46:47], v[118:119] op_sel:[1,1,0] op_sel_hi:[0,1,1] neg_lo:[1,0,0]
    v_cvt_pk_bf16_f32 v127, v118, -v119
    ds_write_addtid_b32 v127 offset:2992
    v_pk_mul_f32 v[116:117], v[120:121], v[46:47] op_sel_hi:[1,0]
    v_pk_fma_f32 v[116:117], v[120:121], v[46:47], v[116:117] op_sel:[1,1,0] op_sel_hi:[0,1,1] neg_lo:[1,0,0]
    v_cvt_pk_bf16_f32 v124, v116, -v117
    ds_write_addtid_b32 v124 offset:3264
    v_pk_mul_f32 v[122:123], v[118:119], v[46:47] op_sel_hi:[1,0]
    v_pk_fma_f32 v[122:123], v[118:119], v[46:47], v[122:123] op_sel:[1,1,0] op_sel_hi:[0,1,1] neg_lo:[1,0,0]
    v_cvt_pk_bf16_f32 v125, v122, -v123
    ds_write_addtid_b32 v125 offset:3536
    v_pk_mul_f32 v[120:121], v[116:117], v[46:47] op_sel_hi:[1,0]
    v_pk_fma_f32 v[120:121], v[116:117], v[46:47], v[120:121] op_sel:[1,1,0] op_sel_hi:[0,1,1] neg_lo:[1,0,0]
    v_cvt_pk_bf16_f32 v126, v120, -v121
    ds_write_addtid_b32 v126 offset:3808
    v_pk_mul_f32 v[118:119], v[122:123], v[46:47] op_sel_hi:[1,0]
    v_pk_fma_f32 v[118:119], v[122:123], v[46:47], v[118:119] op_sel:[1,1,0] op_sel_hi:[0,1,1] neg_lo:[1,0,0]
    v_cvt_pk_bf16_f32 v127, v118, -v119
    ds_write_addtid_b32 v127 offset:4080
    v_mov_b32 v52, v50
    v_mov_b32 v53, v51
    v_cvt_pk_bf16_f32 v124, v52, v53
    ds_write_addtid_b32 v124 offset:4352
    v_pk_mul_f32 v[54:55], v[52:53], v[40:41] op_sel_hi:[1,0]
    v_pk_fma_f32 v[54:55], v[52:53], v[40:41], v[54:55] op_sel:[1,1,0] op_sel_hi:[0,1,1] neg_lo:[1,0,0]
    v_cvt_pk_bf16_f32 v125, v54, v55
    ds_write_addtid_b32 v125 offset:4624
    v_pk_mul_f32 v[56:57], v[54:55], v[40:41] op_sel_hi:[1,0]
    v_pk_fma_f32 v[56:57], v[54:55], v[40:41], v[56:57] op_sel:[1,1,0] op_sel_hi:[0,1,1] neg_lo:[1,0,0]
    v_cvt_pk_bf16_f32 v126, v56, v57
    ds_write_addtid_b32 v126 offset:4896
    v_pk_mul_f32 v[58:59], v[56:57], v[40:41] op_sel_hi:[1,0]
    v_pk_fma_f32 v[58:59], v[56:57], v[40:41], v[58:59] op_sel:[1,1,0] op_sel_hi:[0,1,1] neg_lo:[1,0,0]
    v_cvt_pk_bf16_f32 v127, v58, v59
    ds_write_addtid_b32 v127 offset:5168
    v_pk_mul_f32 v[60:61], v[58:59], v[40:41] op_sel_hi:[1,0]
    v_pk_fma_f32 v[60:61], v[58:59], v[40:41], v[60:61] op_sel:[1,1,0] op_sel_hi:[0,1,1] neg_lo:[1,0,0]
    v_cvt_pk_bf16_f32 v124, v60, v61
    ds_write_addtid_b32 v124 offset:5440
    v_pk_mul_f32 v[62:63], v[60:61], v[40:41] op_sel_hi:[1,0]
    v_pk_fma_f32 v[62:63], v[60:61], v[40:41], v[62:63] op_sel:[1,1,0] op_sel_hi:[0,1,1] neg_lo:[1,0,0]
    v_cvt_pk_bf16_f32 v125, v62, v63
    ds_write_addtid_b32 v125 offset:5712
    v_pk_mul_f32 v[64:65], v[62:63], v[40:41] op_sel_hi:[1,0]
    v_pk_fma_f32 v[64:65], v[62:63], v[40:41], v[64:65] op_sel:[1,1,0] op_sel_hi:[0,1,1] neg_lo:[1,0,0]
    v_cvt_pk_bf16_f32 v126, v64, v65
    ds_write_addtid_b32 v126 offset:5984
    v_pk_mul_f32 v[66:67], v[64:65], v[40:41] op_sel_hi:[1,0]
    v_pk_fma_f32 v[66:67], v[64:65], v[40:41], v[66:67] op_sel:[1,1,0] op_sel_hi:[0,1,1] neg_lo:[1,0,0]
    v_cvt_pk_bf16_f32 v127, v66, v67
    ds_write_addtid_b32 v127 offset:6256
    v_pk_mul_f32 v[68:69], v[52:53], v[44:45] op_sel_hi:[1,0]
    v_pk_fma_f32 v[68:69], v[52:53], v[44:45], v[68:69] op_sel:[1,1,0] op_sel_hi:[0,1,1] neg_lo:[1,0,0]
    v_cvt_pk_bf16_f32 v124, v68, v69
    ds_write_addtid_b32 v124 offset:6528
    v_pk_mul_f32 v[70:71], v[54:55], v[44:45] op_sel_hi:[1,0]
    v_pk_fma_f32 v[70:71], v[54:55], v[44:45], v[70:71] op_sel:[1,1,0] op_sel_hi:[0,1,1] neg_lo:[1,0,0]
    v_cvt_pk_bf16_f32 v125, v70, v71
    ds_write_addtid_b32 v125 offset:6800
    v_pk_mul_f32 v[72:73], v[56:57], v[44:45] op_sel_hi:[1,0]
    v_pk_fma_f32 v[72:73], v[56:57], v[44:45], v[72:73] op_sel:[1,1,0] op_sel_hi:[0,1,1] neg_lo:[1,0,0]
    v_cvt_pk_bf16_f32 v126, v72, v73
    ds_write_addtid_b32 v126 offset:7072
    v_pk_mul_f32 v[74:75], v[58:59], v[44:45] op_sel_hi:[1,0]
    v_pk_fma_f32 v[74:75], v[58:59], v[44:45], v[74:75] op_sel:[1,1,0] op_sel_hi:[0,1,1] neg_lo:[1,0,0]
    v_cvt_pk_bf16_f32 v127, v74, v75
    ds_write_addtid_b32 v127 offset:7344
    v_pk_mul_f32 v[76:77], v[60:61], v[44:45] op_sel_hi:[1,0]
    v_pk_fma_f32 v[76:77], v[60:61], v[44:45], v[76:77] op_sel:[1,1,0] op_sel_hi:[0,1,1] neg_lo:[1,0,0]
    v_cvt_pk_bf16_f32 v124, v76, v77
    ds_write_addtid_b32 v124 offset:7616
    v_pk_mul_f32 v[78:79], v[62:63], v[44:45] op_sel_hi:[1,0]
    v_pk_fma_f32 v[78:79], v[62:63], v[44:45], v[78:79] op_sel:[1,1,0] op_sel_hi:[0,1,1] neg_lo:[1,0,0]
    v_cvt_pk_bf16_f32 v125, v78, v79
    ds_write_addtid_b32 v125 offset:7888
    v_pk_mul_f32 v[80:81], v[64:65], v[44:45] op_sel_hi:[1,0]
    v_pk_fma_f32 v[80:81], v[64:65], v[44:45], v[80:81] op_sel:[1,1,0] op_sel_hi:[0,1,1] neg_lo:[1,0,0]
    v_cvt_pk_bf16_f32 v126, v80, v81
    ds_write_addtid_b32 v126 offset:8160
    v_pk_mul_f32 v[82:83], v[66:67], v[44:45] op_sel_hi:[1,0]
    v_pk_fma_f32 v[82:83], v[66:67], v[44:45], v[82:83] op_sel:[1,1,0] op_sel_hi:[0,1,1] neg_lo:[1,0,0]
    v_cvt_pk_bf16_f32 v127, v82, v83
    ds_write_addtid_b32 v127 offset:8432
    ds_read_b128 a[16:19], v9 offset:0
    ds_read_b128 a[20:23], v9 offset:64
    ds_read_b128 a[24:27], v9 offset:128
    ds_read_b128 a[28:31], v9 offset:192
    ds_read_b128 a[32:35], v9 offset:4352
    ds_read_b128 a[36:39], v9 offset:4416
    ds_read_b128 a[40:43], v9 offset:4480
    ds_read_b128 a[44:47], v9 offset:4544
    v_pk_mul_f32 v[84:85], v[68:69], v[44:45] op_sel_hi:[1,0]
    v_pk_fma_f32 v[84:85], v[68:69], v[44:45], v[84:85] op_sel:[1,1,0] op_sel_hi:[0,1,1] neg_lo:[1,0,0]
    v_pk_mul_f32 v[86:87], v[72:73], v[44:45] op_sel_hi:[1,0]
    v_pk_fma_f32 v[86:87], v[72:73], v[44:45], v[86:87] op_sel:[1,1,0] op_sel_hi:[0,1,1] neg_lo:[1,0,0]
    v_pk_mul_f32 v[88:89], v[76:77], v[44:45] op_sel_hi:[1,0]
    v_pk_fma_f32 v[88:89], v[76:77], v[44:45], v[88:89] op_sel:[1,1,0] op_sel_hi:[0,1,1] neg_lo:[1,0,0]
    v_pk_mul_f32 v[90:91], v[80:81], v[44:45] op_sel_hi:[1,0]
    v_pk_fma_f32 v[90:91], v[80:81], v[44:45], v[90:91] op_sel:[1,1,0] op_sel_hi:[0,1,1] neg_lo:[1,0,0]
    v_pk_mul_f32 v[92:93], v[84:85], v[44:45] op_sel_hi:[1,0]
    v_pk_fma_f32 v[92:93], v[84:85], v[44:45], v[92:93] op_sel:[1,1,0] op_sel_hi:[0,1,1] neg_lo:[1,0,0]
    v_pk_mul_f32 v[94:95], v[86:87], v[44:45] op_sel_hi:[1,0]
    v_pk_fma_f32 v[94:95], v[86:87], v[44:45], v[94:95] op_sel:[1,1,0] op_sel_hi:[0,1,1] neg_lo:[1,0,0]
    v_pk_mul_f32 v[96:97], v[88:89], v[44:45] op_sel_hi:[1,0]
    v_pk_fma_f32 v[96:97], v[88:89], v[44:45], v[96:97] op_sel:[1,1,0] op_sel_hi:[0,1,1] neg_lo:[1,0,0]
    v_pk_mul_f32 v[98:99], v[90:91], v[44:45] op_sel_hi:[1,0]
    v_pk_fma_f32 v[98:99], v[90:91], v[44:45], v[98:99] op_sel:[1,1,0] op_sel_hi:[0,1,1] neg_lo:[1,0,0]
    v_pk_mul_f32 v[100:101], v[92:93], v[44:45] op_sel_hi:[1,0]
    v_pk_fma_f32 v[100:101], v[92:93], v[44:45], v[100:101] op_sel:[1,1,0] op_sel_hi:[0,1,1] neg_lo:[1,0,0]
    v_pk_mul_f32 v[102:103], v[96:97], v[44:45] op_sel_hi:[1,0]
    v_pk_fma_f32 v[102:103], v[96:97], v[44:45], v[102:103] op_sel:[1,1,0] op_sel_hi:[0,1,1] neg_lo:[1,0,0]
    v_pk_mul_f32 v[104:105], v[100:101], v[44:45] op_sel_hi:[1,0]
    v_pk_fma_f32 v[104:105], v[100:101], v[44:45], v[104:105] op_sel:[1,1,0] op_sel_hi:[0,1,1] neg_lo:[1,0,0]
    v_pk_mul_f32 v[106:107], v[102:103], v[44:45] op_sel_hi:[1,0]
    v_pk_fma_f32 v[106:107], v[102:103], v[44:45], v[106:107] op_sel:[1,1,0] op_sel_hi:[0,1,1] neg_lo:[1,0,0]
    v_pk_mul_f32 v[108:109], v[104:105], v[44:45] op_sel_hi:[1,0]
    v_pk_fma_f32 v[108:109], v[104:105], v[44:45], v[108:109] op_sel:[1,1,0] op_sel_hi:[0,1,1] neg_lo:[1,0,0]
    v_pk_mul_f32 v[110:111], v[106:107], v[44:45] op_sel_hi:[1,0]
    v_pk_fma_f32 v[110:111], v[106:107], v[44:45], v[110:111] op_sel:[1,1,0] op_sel_hi:[0,1,1] neg_lo:[1,0,0]
    v_pk_mul_f32 v[112:113], v[108:109], v[44:45] op_sel_hi:[1,0]
    v_pk_fma_f32 v[112:113], v[108:109], v[44:45], v[112:113] op_sel:[1,1,0] op_sel_hi:[0,1,1] neg_lo:[1,0,0]
    v_pk_mul_f32 v[114:115], v[110:111], v[44:45] op_sel_hi:[1,0]
    v_pk_fma_f32 v[114:115], v[110:111], v[44:45], v[114:115] op_sel:[1,1,0] op_sel_hi:[0,1,1] neg_lo:[1,0,0]
    s_waitcnt lgkmcnt(3)
    v_mfma_f32_16x16x32_bf16 a[0:3], a[32:35], a[16:19], a[0:3]
    s_waitcnt lgkmcnt(2)
    v_mfma_f32_16x16x32_bf16 a[0:3], a[36:39], a[20:23], a[0:3]
    s_waitcnt lgkmcnt(1)
    v_mfma_f32_16x16x32_bf16 a[0:3], a[40:43], a[24:27], a[0:3]
    s_waitcnt lgkmcnt(0)
    v_mfma_f32_16x16x32_bf16 a[0:3], a[44:47], a[28:31], a[0:3]
    v_cvt_pk_bf16_f32 v124, v84, v85
    ds_write_addtid_b32 v124 offset:4352
    v_cvt_pk_bf16_f32 v125, v86, v87
    ds_write_addtid_b32 v125 offset:4624
    v_cvt_pk_bf16_f32 v126, v88, v89
    ds_write_addtid_b32 v126 offset:4896
    v_cvt_pk_bf16_f32 v127, v90, v91
    ds_write_addtid_b32 v127 offset:5168
    v_cvt_pk_bf16_f32 v124, v92, v93
    ds_write_addtid_b32 v124 offset:5440
    v_cvt_pk_bf16_f32 v125, v94, v95
    ds_write_addtid_b32 v125 offset:5712
    v_cvt_pk_bf16_f32 v126, v96, v97
    ds_write_addtid_b32 v126 offset:5984
    v_cvt_pk_bf16_f32 v127, v98, v99
    ds_write_addtid_b32 v127 offset:6256
    s_waitcnt vmcnt(0)
    s_barrier
    s_cmp_lg_u32 s58, 0
    s_cbranch_scc1 L_pw7
    s_lshl_b32 s75, s3, 2
    s_add_u32 s75, s75, 13893632
    v_mov_b32 v28, s80
    v_mov_b32 v29, s75
    s_mov_b64 exec, 1
    buffer_store_dword v28, v29, s[36:39], 0 offen sc0 sc1
    s_mov_b64 exec, -1
L_pw7:
    s_mov_b32 m0, s92
    v_cvt_pk_bf16_f32 v124, v100, v101
    ds_write_addtid_b32 v124 offset:6528
    v_cvt_pk_bf16_f32 v125, v102, v103
    ds_write_addtid_b32 v125 offset:6800
    v_cvt_pk_bf16_f32 v126, v104, v105
    ds_write_addtid_b32 v126 offset:7072
    v_cvt_pk_bf16_f32 v127, v106, v107
    ds_write_addtid_b32 v127 offset:7344
    v_cvt_pk_bf16_f32 v124, v108, v109
    ds_write_addtid_b32 v124 offset:7616
    v_cvt_pk_bf16_f32 v125, v110, v111
    ds_write_addtid_b32 v125 offset:7888
    v_cvt_pk_bf16_f32 v126, v112, v113
    ds_write_addtid_b32 v126 offset:8160
    v_cvt_pk_bf16_f32 v127, v114, v115
    ds_write_addtid_b32 v127 offset:8432
    ds_read_b128 a[32:35], v9 offset:4352
    ds_read_b128 a[36:39], v9 offset:4416
    ds_read_b128 a[40:43], v9 offset:4480
    ds_read_b128 a[44:47], v9 offset:4544
    v_pk_mul_f32 v[52:53], v[112:113], v[44:45] op_sel_hi:[1,0]
    v_pk_fma_f32 v[52:53], v[112:113], v[44:45], v[52:53] op_sel:[1,1,0] op_sel_hi:[0,1,1] neg_lo:[1,0,0]
    v_pk_mul_f32 v[54:55], v[52:53], v[44:45] op_sel_hi:[1,0]
    v_pk_fma_f32 v[54:55], v[52:53], v[44:45], v[54:55] op_sel:[1,1,0] op_sel_hi:[0,1,1] neg_lo:[1,0,0]
    v_pk_mul_f32 v[56:57], v[52:53], v[48:49] op_sel_hi:[1,0]
    v_pk_fma_f32 v[56:57], v[52:53], v[48:49], v[56:57] op_sel:[1,1,0] op_sel_hi:[0,1,1] neg_lo:[1,0,0]
    v_pk_mul_f32 v[58:59], v[54:55], v[48:49] op_sel_hi:[1,0]
    v_pk_fma_f32 v[58:59], v[54:55], v[48:49], v[58:59] op_sel:[1,1,0] op_sel_hi:[0,1,1] neg_lo:[1,0,0]
    v_pk_mul_f32 v[60:61], v[56:57], v[48:49] op_sel_hi:[1,0]
    v_pk_fma_f32 v[60:61], v[56:57], v[48:49], v[60:61] op_sel:[1,1,0] op_sel_hi:[0,1,1] neg_lo:[1,0,0]
    v_pk_mul_f32 v[62:63], v[58:59], v[48:49] op_sel_hi:[1,0]
    v_pk_fma_f32 v[62:63], v[58:59], v[48:49], v[62:63] op_sel:[1,1,0] op_sel_hi:[0,1,1] neg_lo:[1,0,0]
    v_pk_mul_f32 v[64:65], v[60:61], v[48:49] op_sel_hi:[1,0]
    v_pk_fma_f32 v[64:65], v[60:61], v[48:49], v[64:65] op_sel:[1,1,0] op_sel_hi:[0,1,1] neg_lo:[1,0,0]
    v_pk_mul_f32 v[66:67], v[62:63], v[48:49] op_sel_hi:[1,0]
    v_pk_fma_f32 v[66:67], v[62:63], v[48:49], v[66:67] op_sel:[1,1,0] op_sel_hi:[0,1,1] neg_lo:[1,0,0]
    v_pk_mul_f32 v[68:69], v[64:65], v[48:49] op_sel_hi:[1,0]
    v_pk_fma_f32 v[68:69], v[64:65], v[48:49], v[68:69] op_sel:[1,1,0] op_sel_hi:[0,1,1] neg_lo:[1,0,0]
    s_waitcnt lgkmcnt(3)
    v_mfma_f32_16x16x32_bf16 a[4:7], a[32:35], a[16:19], a[4:7]
    s_waitcnt lgkmcnt(2)
    v_mfma_f32_16x16x32_bf16 a[4:7], a[36:39], a[20:23], a[4:7]
    s_waitcnt lgkmcnt(1)
    v_mfma_f32_16x16x32_bf16 a[4:7], a[40:43], a[24:27], a[4:7]
    s_waitcnt lgkmcnt(0)
    v_mfma_f32_16x16x32_bf16 a[4:7], a[44:47], a[28:31], a[4:7]
    v_cvt_pk_bf16_f32 v124, v52, v53
    ds_write_addtid_b32 v124 offset:4352
    v_cvt_pk_bf16_f32 v125, v54, v55
    ds_write_addtid_b32 v125 offset:4624
    v_cvt_pk_bf16_f32 v126, v56, v57
    ds_write_addtid_b32 v126 offset:4896
    v_cvt_pk_bf16_f32 v127, v58, v59
    ds_write_addtid_b32 v127 offset:5168
    v_cvt_pk_bf16_f32 v124, v60, v61
    ds_write_addtid_b32 v124 offset:5440
    v_cvt_pk_bf16_f32 v125, v62, v63
    ds_write_addtid_b32 v125 offset:5712
    v_cvt_pk_bf16_f32 v126, v64, v65
    ds_write_addtid_b32 v126 offset:5984
    v_cvt_pk_bf16_f32 v127, v66, v67
    ds_write_addtid_b32 v127 offset:6256
    v_cvt_pk_bf16_f32 v124, v68, v69
    ds_write_addtid_b32 v124 offset:6528
    ds_read_b128 a[32:35], v9 offset:4352
    ds_read_b128 a[36:39], v9 offset:4416
    ds_read_b128 a[40:43], v9 offset:4480
    ds_read_b128 a[44:47], v9 offset:4544
    s_waitcnt lgkmcnt(3)
    v_mfma_f32_16x16x32_bf16 a[8:11], a[32:35], a[16:19], a[8:11]
    s_waitcnt lgkmcnt(2)
    v_mfma_f32_16x16x32_bf16 a[8:11], a[36:39], a[20:23], a[8:11]
    s_waitcnt lgkmcnt(1)
    v_mfma_f32_16x16x32_bf16 a[8:11], a[40:43], a[24:27], a[8:11]
    s_waitcnt lgkmcnt(0)
    v_mfma_f32_16x16x32_bf16 a[8:11], a[44:47], a[28:31], a[8:11]
    v_add_u32 v11, s92, v10
    ds_write_b128 v11, a[0:3] offset:0
    ds_write_b128 v11, a[4:7] offset:1024
    s_nop 4
    ds_write_b128 v11, a[8:11] offset:2048
    s_waitcnt lgkmcnt(0)
    s_barrier
    s_xor_b32 s75, s58, 1
    s_mul_i32 s75, s75, 8704
    s_add_u32 s75, s75, 0
    v_add_u32_e64 v11, s75, v10
    ds_read_b128 v[52:55], v11 offset:0
    ds_read_b128 v[56:59], v11 offset:1024
    ds_read_b128 v[60:63], v11 offset:2048
    v_accvgpr_read_b32 v64, a0
    v_accvgpr_read_b32 v65, a1
    v_accvgpr_read_b32 v66, a2
    v_accvgpr_read_b32 v67, a3
    v_accvgpr_read_b32 v68, a4
    v_accvgpr_read_b32 v69, a5
    v_accvgpr_read_b32 v70, a6
    v_accvgpr_read_b32 v71, a7
    v_accvgpr_read_b32 v72, a8
    v_accvgpr_read_b32 v73, a9
    v_accvgpr_read_b32 v74, a10
    v_accvgpr_read_b32 v75, a11
    s_lshr_b32 s74, s58, 1
    s_mul_i32 s74, s74, 2816
    s_add_u32 s74, s74, 34820
    v_and_b32 v11, 15, v0
    v_lshrrev_b32 v12, 4, v0
    v_and_b32 v14, 1, v12
    v_lshlrev_b32 v14, 4, v14
    v_lshrrev_b32 v15, 1, v12
    v_lshl_add_u32 v14, v15, 9, v14
    v_lshl_add_u32 v14, v11, 5, v14
    v_add_u32 v16, s74, v14
    v_lshlrev_b32 v14, 8, v12
    v_add_u32 v14, 1024, v14
    v_lshlrev_b32 v15, 4, v11
    v_lshlrev_b32 v17, 3, v11
    v_cndmask_b32 v15, v15, v17, s[84:85]
    v_add3_u32 v17, v14, v15, s74
    v_mov_b32_e64 v14, 8
    v_mov_b32 v15, 128
    v_cndmask_b32 v14, v14, v15, s[84:85]
    v_add_u32 v18, v17, v14
    v_lshlrev_b32 v14, 8, v12
    v_lshl_add_u32 v14, v11, 2, v14
    v_add_u32 v14, 2048, v14
    v_add_u32 v19, s74, v14
    s_sub_u32 s74, s74, 4
    v_mov_b32 v20, s74
    v_mov_b32_e64 v21, 0
    s_waitcnt lgkmcnt(2)
    v_pk_add_f32 v[64:65], v[64:65], v[52:53]
    v_pk_add_f32 v[66:67], v[66:67], v[54:55]
    s_waitcnt lgkmcnt(1)
    v_pk_add_f32 v[68:69], v[68:69], v[56:57]
    v_pk_add_f32 v[70:71], v[70:71], v[58:59]
    s_waitcnt lgkmcnt(0)
    v_pk_add_f32 v[72:73], v[72:73], v[60:61]
    v_pk_add_f32 v[74:75], v[74:75], v[62:63]
    ds_write_b32 v20, v21
    ds_write_b32 v16, v64 offset:0
    ds_write_b32 v16, v65 offset:4
    ds_write_b32 v16, v66 offset:8
    ds_write_b32 v16, v67 offset:12
    ds_write_b32 v17, v68
    ds_write_b32 v17, v69 offset:4
    ds_write_b32 v18, v70
    ds_write_b32 v18, v71 offset:4
    s_mov_b32 exec_hi, 0xffff
    ds_write_b32 v19, v72
    s_mov_b32 exec_hi, 0
    ds_write_b32 v19, v73 offset:64
    ds_write_b32 v19, v74 offset:128
    ds_write_b32 v19, v75 offset:192
    s_mov_b64 exec, -1
    s_and_b32 s74, s58, 1
    s_lshl_b32 s74, s74, 10
    s_sub_u32 s74, 2047, s74
    v_lshlrev_b32 v11, 4, v0
    v_sub_u32 v11, s74, v11
    v_cvt_f32_u32_e64 v12, v11
    v_add_u32 v11, 0x4280, v11
    v_mov_b32 v14, 0x427f
    v_mov_b32 v15, 0x42ff
    s_lshr_b32 s74, s58, 1
    s_mul_i32 s74, s74, 2816
    s_add_u32 s74, s74, 4294934020
    v_add_f32 v16, -1.0, v12
    v_cvt_pk_bf16_f32 v17, v12, v16
    v_med3_i32 v18, v11, v14, v15
    v_max_i32_sdwa v18, v17, v18 dst_sel:DWORD dst_unused:UNUSED_PAD src0_sel:WORD_0 src1_sel:DWORD
    v_lshl_add_u32 v104, v18, 2, s74
    v_add_u32 v11, -1, v11
    v_med3_i32 v18, v11, v14, v15
    v_max_i32_sdwa v18, v17, v18 dst_sel:DWORD dst_unused:UNUSED_PAD src0_sel:WORD_1 src1_sel:DWORD
    v_lshl_add_u32 v105, v18, 2, s74
    v_add_u32 v11, -1, v11
    v_add_f32 v12, -2.0, v12
    v_add_f32 v16, -1.0, v12
    v_cvt_pk_bf16_f32 v17, v12, v16
    v_med3_i32 v18, v11, v14, v15
    v_max_i32_sdwa v18, v17, v18 dst_sel:DWORD dst_unused:UNUSED_PAD src0_sel:WORD_0 src1_sel:DWORD
    v_lshl_add_u32 v106, v18, 2, s74
    v_add_u32_e64 v11, -1, v11
    v_med3_i32 v18, v11, v14, v15
    v_max_i32_sdwa v18, v17, v18 dst_sel:DWORD dst_unused:UNUSED_PAD src0_sel:WORD_1 src1_sel:DWORD
    v_lshl_add_u32 v107, v18, 2, s74
    v_add_u32 v11, -1, v11
    v_add_f32 v12, -2.0, v12
    v_add_f32_e64 v16, -1.0, v12
    v_cvt_pk_bf16_f32 v17, v12, v16
    v_med3_i32 v18, v11, v14, v15
    v_max_i32_sdwa v18, v17, v18 dst_sel:DWORD dst_unused:UNUSED_PAD src0_sel:WORD_0 src1_sel:DWORD
    v_lshl_add_u32 v108, v18, 2, s74
    v_add_u32_e64 v11, -1, v11
    v_med3_i32 v18, v11, v14, v15
    v_max_i32_sdwa v18, v17, v18 dst_sel:DWORD dst_unused:UNUSED_PAD src0_sel:WORD_1 src1_sel:DWORD
    v_lshl_add_u32 v109, v18, 2, s74
    v_add_u32 v11, -1, v11
    v_add_f32 v12, -2.0, v12
    v_add_f32_e64 v16, -1.0, v12
    v_cvt_pk_bf16_f32 v17, v12, v16
    v_med3_i32 v18, v11, v14, v15
    v_max_i32_sdwa v18, v17, v18 dst_sel:DWORD dst_unused:UNUSED_PAD src0_sel:WORD_0 src1_sel:DWORD
    v_lshl_add_u32 v110, v18, 2, s74
    v_add_u32_e64 v11, -1, v11
    v_med3_i32 v18, v11, v14, v15
    v_max_i32_sdwa v18, v17, v18 dst_sel:DWORD dst_unused:UNUSED_PAD src0_sel:WORD_1 src1_sel:DWORD
    v_lshl_add_u32 v111, v18, 2, s74
    v_add_u32 v11, -1, v11
    v_add_f32 v12, -2.0, v12
    v_add_f32_e64 v16, -1.0, v12
    v_cvt_pk_bf16_f32 v17, v12, v16
    v_med3_i32 v18, v11, v14, v15
    v_max_i32_sdwa v18, v17, v18 dst_sel:DWORD dst_unused:UNUSED_PAD src0_sel:WORD_0 src1_sel:DWORD
    v_lshl_add_u32 v112, v18, 2, s74
    v_add_u32_e64 v11, -1, v11
    v_med3_i32 v18, v11, v14, v15
    v_max_i32_sdwa v18, v17, v18 dst_sel:DWORD dst_unused:UNUSED_PAD src0_sel:WORD_1 src1_sel:DWORD
    v_lshl_add_u32 v113, v18, 2, s74
    v_add_u32 v11, -1, v11
    v_add_f32 v12, -2.0, v12
    v_add_f32_e64 v16, -1.0, v12
    v_cvt_pk_bf16_f32 v17, v12, v16
    v_med3_i32 v18, v11, v14, v15
    v_max_i32_sdwa v18, v17, v18 dst_sel:DWORD dst_unused:UNUSED_PAD src0_sel:WORD_0 src1_sel:DWORD
    v_lshl_add_u32 v114, v18, 2, s74
    v_add_u32_e64 v11, -1, v11
    v_med3_i32 v18, v11, v14, v15
    v_max_i32_sdwa v18, v17, v18 dst_sel:DWORD dst_unused:UNUSED_PAD src0_sel:WORD_1 src1_sel:DWORD
    v_lshl_add_u32 v115, v18, 2, s74
    v_add_u32 v11, -1, v11
    v_add_f32 v12, -2.0, v12
    v_add_f32_e64 v16, -1.0, v12
    v_cvt_pk_bf16_f32 v17, v12, v16
    v_med3_i32 v18, v11, v14, v15
    v_max_i32_sdwa v18, v17, v18 dst_sel:DWORD dst_unused:UNUSED_PAD src0_sel:WORD_0 src1_sel:DWORD
    v_lshl_add_u32 v116, v18, 2, s74
    v_add_u32_e64 v11, -1, v11
    v_med3_i32 v18, v11, v14, v15
    v_max_i32_sdwa v18, v17, v18 dst_sel:DWORD dst_unused:UNUSED_PAD src0_sel:WORD_1 src1_sel:DWORD
    v_lshl_add_u32 v117, v18, 2, s74
    v_add_u32 v11, -1, v11
    v_add_f32 v12, -2.0, v12
    v_add_f32_e64 v16, -1.0, v12
    v_cvt_pk_bf16_f32 v17, v12, v16
    v_med3_i32 v18, v11, v14, v15
    v_max_i32_sdwa v18, v17, v18 dst_sel:DWORD dst_unused:UNUSED_PAD src0_sel:WORD_0 src1_sel:DWORD
    v_lshl_add_u32 v118, v18, 2, s74
    v_add_u32_e64 v11, -1, v11
    v_med3_i32 v18, v11, v14, v15
    v_max_i32_sdwa v18, v17, v18 dst_sel:DWORD dst_unused:UNUSED_PAD src0_sel:WORD_1 src1_sel:DWORD
    v_lshl_add_u32 v119, v18, 2, s74
    v_add_u32 v11, -1, v11
    v_add_f32 v12, -2.0, v12
    v_add_f32 v16, -1.0, v12
    v_max_f32 v17, 0, v12
    v_max_f32_e64 v18, 0, v16
    v_cvt_pk_bf16_f32 v17, v17, v18
    v_med3_i32 v18, v11, v14, v15
    v_max_i32_sdwa v18, v17, v18 dst_sel:DWORD dst_unused:UNUSED_PAD src0_sel:WORD_0 src1_sel:DWORD
    v_lshl_add_u32 v120, v18, 2, s74
    v_add_u32 v11, -1, v11
    v_med3_i32 v18, v11, v14, v15
    v_max_i32_sdwa v18, v17, v18 dst_sel:DWORD dst_unused:UNUSED_PAD src0_sel:WORD_1 src1_sel:DWORD
    v_lshl_add_u32 v121, v18, 2, s74
    v_add_u32 v11, -1, v11
    v_add_f32 v12, -2.0, v12
    v_add_f32 v16, -1.0, v12
    v_max_f32 v17, 0, v12
    v_max_f32 v18, 0, v16
    v_cvt_pk_bf16_f32 v17, v17, v18
    v_med3_i32 v18, v11, v14, v15
    v_max_i32_sdwa v18, v17, v18 dst_sel:DWORD dst_unused:UNUSED_PAD src0_sel:WORD_0 src1_sel:DWORD
    v_lshl_add_u32 v122, v18, 2, s74
    v_add_u32 v11, -1, v11
    v_add_f32_e64 v12, -2.0, v12
    s_lshl_b32 s75, s90, 7
    s_add_u32 s75, s75, 13893632
    v_and_b32 v27, 31, v0
    v_lshlrev_b32 v27, 2, v27
    v_add_u32 v27, s75, v27
    s_waitcnt lgkmcnt(0)
    s_cmp_lg_u32 s58, 0
    s_cbranch_scc1 L_p08_done
    s_mov_b32 s76, 400000
L_p08:
    buffer_load_dword v26, v27, s[36:39], 0 offen sc0 sc1
    s_waitcnt vmcnt(0)
    v_cmp_ne_u32 vcc, s80, v26
    s_nop 1
    s_cbranch_vccz L_p08_done
    s_sleep 16
    s_sub_u32 s76, s76, 1
    s_cmp_lg_u32 s76, 0
    s_cbranch_scc1 L_p08
L_p08_done:
    s_barrier
    s_lshl_b32 s74, s94, 12
    s_and_b32 s75, s58, 1
    s_lshl_b32 s75, s75, 11
    s_add_u32 s74, s74, s75
    s_add_u32 s74, s74, 4194304
    buffer_load_dwordx4 v[36:39], v10, s[36:39], s74 offen sc0 sc1
    buffer_load_dwordx4 v[40:43], v10, s[36:39], s74 offen offset:1024 sc0 sc1
    v_and_b32 v12, 15, v0
    v_lshrrev_b32 v13, 4, v0
    v_and_b32 v14, 1, v13
    v_lshrrev_b32 v15, 1, v13
    v_sub_u32 v24, 2047, v12
    v_lshl_add_u32 v24, v14, 3, v24
    v_lshlrev_b32 v25, 4, v15
    v_sub_u32 v24, v24, v25
    v_and_b32 v25, 3, v24
    v_sub_u32 v24, v24, v25
    v_mul_u32_u24 v25, 4160, v25
    v_lshl_add_u32 v24, v24, 1, v25
    s_lshr_b32 s74, s58, 1
    s_mul_i32 s75, s74, 16640
    s_and_b32 s76, s58, 1
    s_lshl_b32 s76, s76, 8
    s_add_u32 s75, s75, 0
    s_sub_u32 s75, s75, s76
    s_sub_u32 s75, s75, 3776
    v_add_u32 v8, s75, v24
    v_sub_u32 v24, v12, v15
    v_lshlrev_b32_e64 v24, 5, v24
    v_lshl_add_u32 v24, v14, 4, v24
    s_mul_i32 s75, s74, 4608
    s_add_u32 s77, s75, 40960
    s_add_u32 s75, s75, 41280
    s_sub_u32 s75, s75, s76
    v_add_u32 v9, s75, v24
    s_and_b32 s75, s58, 1
    s_lshl_b32 s75, s75, 11
    s_add_u32 s74, s77, s75
    v_add_u32 v4, s74, v10
    v_lshl_add_u32 v5, v0, 3, s77
    ds_read_b32 v52, v104
    ds_read_b32 v53, v105
    ds_read_b32 v54, v106
    ds_read_b32 v55, v107
    ds_read_b32 v56, v108
    ds_read_b32 v57, v109
    ds_read_b32 v58, v110
    ds_read_b32 v59, v111
    ds_read_b32 v60, v112
    ds_read_b32 v61, v113
    ds_read_b32 v62, v114
    ds_read_b32 v63, v115
    ds_read_b32 v64, v116
    ds_read_b32 v65, v117
    ds_read_b32 v66, v118
    ds_read_b32 v67, v119
    ds_read_b32 v68, v120
    ds_read_b32 v69, v121
    ds_read_b32 v70, v122
    s_lshr_b32 s74, s58, 1
    s_mul_i32 s76, s74, 16640
    s_and_b32 s75, s58, 1
    s_lshl_b32 s75, s75, 11
    s_add_u32 s74, s76, s75
    s_add_u32 s74, s74, 0
    v_lshl_add_u32 v11, v0, 5, s74
    v_mov_b32 v16, 0
    v_mov_b32 v17, 0
    v_mov_b32 v18, 0
    v_mov_b32_e64 v19, 0
    s_add_u32 s76, s76, 4096
    v_bfe_u32 v12, v0, 2, 2
    v_mul_u32_u24 v12, 4160, v12
    v_and_b32_e64 v14, 3, v0
    v_lshl_add_u32 v12, v14, 4, v12
    v_add_u32 v12, s76, v12
    ds_write_b128 v12, v[16:19]
    s_waitcnt lgkmcnt(15)
    v_cvt_pk_bf16_f32 v72, v52, v53
    v_cvt_pk_bf16_f32 v73, v54, v55
    s_waitcnt lgkmcnt(14)
    v_cvt_pk_bf16_f32 v74, v56, v57
    s_waitcnt lgkmcnt(12)
    v_cvt_pk_bf16_f32 v75, v58, v59
    s_waitcnt lgkmcnt(10)
    v_cvt_pk_bf16_f32 v76, v60, v61
    s_waitcnt lgkmcnt(8)
    v_cvt_pk_bf16_f32 v77, v62, v63
    s_waitcnt lgkmcnt(6)
    v_cvt_pk_bf16_f32 v78, v64, v65
    s_waitcnt lgkmcnt(4)
    v_cvt_pk_bf16_f32 v79, v66, v67
    ds_write_b128 v11, v[72:75] offset:0
    ds_write_b128 v11, v[76:79] offset:16
    v_cvt_pk_bf16_f32 v80, v53, v54
    v_cvt_pk_bf16_f32 v81, v55, v56
    v_cvt_pk_bf16_f32 v82, v57, v58
    v_cvt_pk_bf16_f32 v83, v59, v60
    v_cvt_pk_bf16_f32 v84, v61, v62
    v_cvt_pk_bf16_f32 v85, v63, v64
    v_cvt_pk_bf16_f32 v86, v65, v66
    s_waitcnt lgkmcnt(5)
    s_nop 0
    v_cvt_pk_bf16_f32 v87, v67, v68
    ds_write_b128 v11, v[80:83] offset:4160
    ds_write_b128 v11, v[84:87] offset:4176
    v_cvt_pk_bf16_f32 v88, v54, v55
    v_cvt_pk_bf16_f32 v89, v56, v57
    v_cvt_pk_bf16_f32 v90, v58, v59
    v_cvt_pk_bf16_f32 v91, v60, v61
    v_cvt_pk_bf16_f32 v92, v62, v63
    v_cvt_pk_bf16_f32 v93, v64, v65
    v_cvt_pk_bf16_f32 v94, v66, v67
    s_waitcnt lgkmcnt(6)
    v_cvt_pk_bf16_f32 v95, v68, v69
    s_nop 0
    ds_write_b128 v11, v[88:91] offset:8320
    ds_write_b128 v11, v[92:95] offset:8336
    v_cvt_pk_bf16_f32 v96, v55, v56
    v_cvt_pk_bf16_f32 v97, v57, v58
    v_cvt_pk_bf16_f32 v98, v59, v60
    v_cvt_pk_bf16_f32 v99, v61, v62
    v_cvt_pk_bf16_f32 v100, v63, v64
    v_cvt_pk_bf16_f32 v101, v65, v66
    v_cvt_pk_bf16_f32 v102, v67, v68
    s_waitcnt lgkmcnt(7)
    v_cvt_pk_bf16_f32 v103, v69, v70
    ds_write_b128 v11, v[96:99] offset:12480
    ds_write_b128 v11, v[100:103] offset:12496
    s_setprio 0
    v_mov_b32 v24, 0
    v_mov_b32_e64 v25, 0
    ds_write_b64 v5, v[24:25]
    s_waitcnt vmcnt(1)
    ds_write_b128 v4, v[36:39] offset:512
    s_waitcnt vmcnt(0)
    ds_write_b128 v4, v[40:43] offset:1536
    s_waitcnt lgkmcnt(0)
    s_barrier
    s_nop 0
    ds_read_b64 a[0:1], v8 offset:3776
    ds_read_b64 a[2:3], v8 offset:3784
    ds_read_b128 a[32:35], v9 offset:192
    ds_read_b64 a[4:5], v8 offset:3264
    ds_read_b64 a[6:7], v8 offset:3272
    ds_read_b128 a[36:39], v9 offset:704
    ds_read_b64 a[8:9], v8 offset:2752
    ds_read_b64 a[10:11], v8 offset:2760
    ds_read_b128 a[40:43], v9 offset:1216
    ds_read_b64 a[12:13], v8 offset:2240
    ds_read_b64 a[14:15], v8 offset:2248
    ds_read_b128 a[44:47], v9 offset:1728
    ds_read_b64 a[16:17], v8 offset:1728
    ds_read_b64 a[18:19], v8 offset:1736
    ds_read_b128 a[48:51], v9 offset:2240
    ds_read_b64 a[20:21], v8 offset:1216
    ds_read_b64 a[22:23], v8 offset:1224
    ds_read_b128 a[52:55], v9 offset:2752
    ds_read_b64 a[24:25], v8 offset:704
    ds_read_b64 a[26:27], v8 offset:712
    ds_read_b128 a[56:59], v9 offset:3264
    ds_read_b64 a[28:29], v8 offset:192
    ds_read_b64 a[30:31], v8 offset:200
    ds_read_b128 a[60:63], v9 offset:3776
    s_waitcnt lgkmcnt(15)
    v_mfma_f32_16x16x32_bf16 v[32:35], a[0:3], a[32:35], 0
    ds_read_b64 a[64:65], v8 offset:3712
    v_mfma_f32_16x16x32_bf16 v[36:39], a[0:3], a[36:39], 0
    s_nop 0
    ds_read_b64 a[66:67], v8 offset:3720
    v_mfma_f32_16x16x32_bf16 v[36:39], a[4:7], a[32:35], v[36:39]
    ds_read_b128 a[96:99], v9 offset:128
    v_mfma_f32_16x16x32_bf16 v[40:43], a[4:7], a[36:39], 0
    ds_read_b64 a[68:69], v8 offset:3200
    v_mfma_f32_16x16x32_bf16 v[40:43], a[0:3], a[40:43], v[40:43]
    v_mfma_f32_16x16x32_bf16 v[40:43], a[8:11], a[32:35], v[40:43]
    ds_read_b64 a[70:71], v8 offset:3208
    v_mfma_f32_16x16x32_bf16 v[44:47], a[4:7], a[40:43], 0
    ds_read_b128 a[100:103], v9 offset:640
    v_mfma_f32_16x16x32_bf16 v[44:47], a[8:11], a[36:39], v[44:47]
    ds_read_b64 a[72:73], v8 offset:2688
    v_mfma_f32_16x16x32_bf16 v[48:51], a[8:11], a[40:43], 0
    s_waitcnt lgkmcnt(15)
    v_mfma_f32_16x16x32_bf16 v[44:47], a[0:3], a[44:47], v[44:47]
    ds_read_b64 a[74:75], v8 offset:2696
    s_nop 0
    v_mfma_f32_16x16x32_bf16 v[44:47], a[12:15], a[32:35], v[44:47]
    ds_read_b128 a[104:107], v9 offset:1152
    v_mfma_f32_16x16x32_bf16 v[48:51], a[4:7], a[44:47], v[48:51]
    ds_read_b64 a[76:77], v8 offset:2176
    v_mfma_f32_16x16x32_bf16 v[48:51], a[12:15], a[36:39], v[48:51]
    ds_read_b64 a[78:79], v8 offset:2184
    v_mfma_f32_16x16x32_bf16 v[52:55], a[8:11], a[44:47], 0
    v_mfma_f32_16x16x32_bf16 v[52:55], a[12:15], a[40:43], v[52:55]
    ds_read_b128 a[108:111], v9 offset:1664
    v_mfma_f32_16x16x32_bf16 v[56:59], a[12:15], a[44:47], 0
    ds_read_b64 a[80:81], v8 offset:1664
    v_mfma_f32_16x16x32_bf16 v[48:51], a[0:3], a[48:51], v[48:51]
    ds_read_b64 a[82:83], v8 offset:1672
    v_mfma_f32_16x16x32_bf16 v[48:51], a[16:19], a[32:35], v[48:51]
    v_mfma_f32_16x16x32_bf16 v[52:55], a[4:7], a[48:51], v[52:55]
    ds_read_b128 a[112:115], v9 offset:2176
    v_mfma_f32_16x16x32_bf16 v[52:55], a[16:19], a[36:39], v[52:55]
    ds_read_b64 a[84:85], v8 offset:1152
    v_mfma_f32_16x16x32_bf16 v[56:59], a[8:11], a[48:51], v[56:59]
    ds_read_b64 a[86:87], v8 offset:1160
    v_mfma_f32_16x16x32_bf16 v[56:59], a[16:19], a[40:43], v[56:59]
    ds_read_b128 a[116:119], v9 offset:2688
    v_mfma_f32_16x16x32_bf16 v[60:63], a[12:15], a[48:51], 0
    v_mfma_f32_16x16x32_bf16 v[60:63], a[16:19], a[44:47], v[60:63]
    ds_read_b64 a[88:89], v8 offset:640
    s_waitcnt lgkmcnt(15)
    v_mfma_f32_16x16x32_bf16 v[52:55], a[0:3], a[52:55], v[52:55]
    ds_read_b64 a[90:91], v8 offset:648
    s_nop 0
    v_mfma_f32_16x16x32_bf16 v[52:55], a[20:23], a[32:35], v[52:55]
    ds_read_b128 a[120:123], v9 offset:3200
    v_mfma_f32_16x16x32_bf16 v[56:59], a[4:7], a[52:55], v[56:59]
    v_mfma_f32_16x16x32_bf16 v[56:59], a[20:23], a[36:39], v[56:59]
    ds_read_b64 a[92:93], v8 offset:128
    v_mfma_f32_16x16x32_bf16 v[60:63], a[8:11], a[52:55], v[60:63]
    ds_read_b64 a[94:95], v8 offset:136
    v_mfma_f32_16x16x32_bf16 v[60:63], a[20:23], a[40:43], v[60:63]
    ds_read_b128 a[124:127], v9 offset:3712
    v_mfma_f32_16x16x32_bf16 v[56:59], a[0:3], a[56:59], v[56:59]
    v_mfma_f32_16x16x32_bf16 v[56:59], a[24:27], a[32:35], v[56:59]
    v_mfma_f32_16x16x32_bf16 v[60:63], a[4:7], a[56:59], v[60:63]
    v_mfma_f32_16x16x32_bf16 v[60:63], a[24:27], a[36:39], v[60:63]
    v_mfma_f32_16x16x32_bf16 v[60:63], a[0:3], a[60:63], v[60:63]
    v_mfma_f32_16x16x32_bf16 v[60:63], a[28:31], a[32:35], v[60:63]
    v_mfma_f32_16x16x32_bf16 v[32:35], a[64:67], a[96:99], v[32:35]
    ds_read_b64 a[0:1], v8 offset:3648
    s_waitcnt lgkmcnt(15)
    v_mfma_f32_16x16x32_bf16 v[36:39], a[64:67], a[100:103], v[36:39]
    ds_read_b64 a[2:3], v8 offset:3656
    s_nop 0
    v_mfma_f32_16x16x32_bf16 v[36:39], a[68:71], a[96:99], v[36:39]
    ds_read_b128 a[32:35], v9 offset:64
    v_mfma_f32_16x16x32_bf16 v[40:43], a[68:71], a[100:103], v[40:43]
    ds_read_b64 a[4:5], v8 offset:3136
    v_mfma_f32_16x16x32_bf16 v[40:43], a[64:67], a[104:107], v[40:43]
    v_mfma_f32_16x16x32_bf16 v[40:43], a[72:75], a[96:99], v[40:43]
    ds_read_b64 a[6:7], v8 offset:3144
    v_mfma_f32_16x16x32_bf16 v[44:47], a[68:71], a[104:107], v[44:47]
    ds_read_b128 a[36:39], v9 offset:576
    v_mfma_f32_16x16x32_bf16 v[44:47], a[72:75], a[100:103], v[44:47]
    ds_read_b64 a[8:9], v8 offset:2624
    v_mfma_f32_16x16x32_bf16 v[48:51], a[72:75], a[104:107], v[48:51]
    s_waitcnt lgkmcnt(15)
    v_mfma_f32_16x16x32_bf16 v[44:47], a[64:67], a[108:111], v[44:47]
    ds_read_b64 a[10:11], v8 offset:2632
    v_mfma_f32_16x16x32_bf16 v[44:47], a[76:79], a[96:99], v[44:47]
    s_nop 0
    ds_read_b128 a[40:43], v9 offset:1088
    v_mfma_f32_16x16x32_bf16 v[48:51], a[68:71], a[108:111], v[48:51]
    ds_read_b64 a[12:13], v8 offset:2112
    v_mfma_f32_16x16x32_bf16 v[48:51], a[76:79], a[100:103], v[48:51]
    ds_read_b64 a[14:15], v8 offset:2120
    v_mfma_f32_16x16x32_bf16 v[52:55], a[72:75], a[108:111], v[52:55]
    v_mfma_f32_16x16x32_bf16 v[52:55], a[76:79], a[104:107], v[52:55]
    ds_read_b128 a[44:47], v9 offset:1600
    v_mfma_f32_16x16x32_bf16 v[56:59], a[76:79], a[108:111], v[56:59]
    ds_read_b64 a[16:17], v8 offset:1600
    v_mfma_f32_16x16x32_bf16 v[48:51], a[64:67], a[112:115], v[48:51]
    ds_read_b64 a[18:19], v8 offset:1608
    v_mfma_f32_16x16x32_bf16 v[48:51], a[80:83], a[96:99], v[48:51]
    v_mfma_f32_16x16x32_bf16 v[52:55], a[68:71], a[112:115], v[52:55]
    ds_read_b128 a[48:51], v9 offset:2112
    v_mfma_f32_16x16x32_bf16 v[52:55], a[80:83], a[100:103], v[52:55]
    ds_read_b64 a[20:21], v8 offset:1088
    v_mfma_f32_16x16x32_bf16 v[56:59], a[72:75], a[112:115], v[56:59]
    ds_read_b64 a[22:23], v8 offset:1096
    v_mfma_f32_16x16x32_bf16 v[56:59], a[80:83], a[104:107], v[56:59]
    ds_read_b128 a[52:55], v9 offset:2624
    v_mfma_f32_16x16x32_bf16 v[60:63], a[76:79], a[112:115], v[60:63]
    v_mfma_f32_16x16x32_bf16 v[60:63], a[80:83], a[108:111], v[60:63]
    ds_read_b64 a[24:25], v8 offset:576
    s_waitcnt lgkmcnt(15)
    v_mfma_f32_16x16x32_bf16 v[52:55], a[64:67], a[116:119], v[52:55]
    ds_read_b64 a[26:27], v8 offset:584
    v_mfma_f32_16x16x32_bf16 v[52:55], a[84:87], a[96:99], v[52:55]
    s_nop 0
    ds_read_b128 a[56:59], v9 offset:3136
    v_mfma_f32_16x16x32_bf16 v[56:59], a[68:71], a[116:119], v[56:59]
    v_mfma_f32_16x16x32_bf16 v[56:59], a[84:87], a[100:103], v[56:59]
    ds_read_b64 a[28:29], v8 offset:64
    v_mfma_f32_16x16x32_bf16 v[60:63], a[72:75], a[116:119], v[60:63]
    ds_read_b64 a[30:31], v8 offset:72
    v_mfma_f32_16x16x32_bf16 v[60:63], a[84:87], a[104:107], v[60:63]
    ds_read_b128 a[60:63], v9 offset:3648
    v_mfma_f32_16x16x32_bf16 v[56:59], a[64:67], a[120:123], v[56:59]
    v_mfma_f32_16x16x32_bf16 v[56:59], a[88:91], a[96:99], v[56:59]
    v_mfma_f32_16x16x32_bf16 v[60:63], a[68:71], a[120:123], v[60:63]
    v_mfma_f32_16x16x32_bf16 v[60:63], a[88:91], a[100:103], v[60:63]
    v_mfma_f32_16x16x32_bf16 v[60:63], a[64:67], a[124:127], v[60:63]
    v_mfma_f32_16x16x32_bf16 v[60:63], a[92:95], a[96:99], v[60:63]
    v_mfma_f32_16x16x32_bf16 v[32:35], a[0:3], a[32:35], v[32:35]
    ds_read_b64 a[64:65], v8 offset:3584
    s_waitcnt lgkmcnt(15)
    v_mfma_f32_16x16x32_bf16 v[36:39], a[0:3], a[36:39], v[36:39]
    ds_read_b64 a[66:67], v8 offset:3592
    v_mfma_f32_16x16x32_bf16 v[36:39], a[4:7], a[32:35], v[36:39]
    s_nop 0
    ds_read_b128 a[96:99], v9 offset:0
    v_mfma_f32_16x16x32_bf16 v[40:43], a[4:7], a[36:39], v[40:43]
    ds_read_b64 a[68:69], v8 offset:3072
    v_mfma_f32_16x16x32_bf16 v[40:43], a[0:3], a[40:43], v[40:43]
    v_mfma_f32_16x16x32_bf16 v[40:43], a[8:11], a[32:35], v[40:43]
    ds_read_b64 a[70:71], v8 offset:3080
    v_mfma_f32_16x16x32_bf16 v[44:47], a[4:7], a[40:43], v[44:47]
    ds_read_b128 a[100:103], v9 offset:512
    v_mfma_f32_16x16x32_bf16 v[44:47], a[8:11], a[36:39], v[44:47]
    ds_read_b64 a[72:73], v8 offset:2560
    v_mfma_f32_16x16x32_bf16 v[48:51], a[8:11], a[40:43], v[48:51]
    s_waitcnt lgkmcnt(15)
    s_nop 0
    v_mfma_f32_16x16x32_bf16 v[44:47], a[0:3], a[44:47], v[44:47]
    ds_read_b64 a[74:75], v8 offset:2568
    v_mfma_f32_16x16x32_bf16 v[44:47], a[12:15], a[32:35], v[44:47]
    ds_read_b128 a[104:107], v9 offset:1024
    v_mfma_f32_16x16x32_bf16 v[48:51], a[4:7], a[44:47], v[48:51]
    ds_read_b64 a[76:77], v8 offset:2048
    v_mfma_f32_16x16x32_bf16 v[48:51], a[12:15], a[36:39], v[48:51]
    ds_read_b64 a[78:79], v8 offset:2056
    v_mfma_f32_16x16x32_bf16 v[52:55], a[8:11], a[44:47], v[52:55]
    v_mfma_f32_16x16x32_bf16 v[52:55], a[12:15], a[40:43], v[52:55]
    ds_read_b128 a[108:111], v9 offset:1536
    v_mfma_f32_16x16x32_bf16 v[56:59], a[12:15], a[44:47], v[56:59]
    ds_read_b64 a[80:81], v8 offset:1536
    v_mfma_f32_16x16x32_bf16 v[48:51], a[0:3], a[48:51], v[48:51]
    ds_read_b64 a[82:83], v8 offset:1544
    v_mfma_f32_16x16x32_bf16 v[48:51], a[16:19], a[32:35], v[48:51]
    v_mfma_f32_16x16x32_bf16 v[52:55], a[4:7], a[48:51], v[52:55]
    ds_read_b128 a[112:115], v9 offset:2048
    v_mfma_f32_16x16x32_bf16 v[52:55], a[16:19], a[36:39], v[52:55]
    ds_read_b64 a[84:85], v8 offset:1024
    v_mfma_f32_16x16x32_bf16 v[56:59], a[8:11], a[48:51], v[56:59]
    ds_read_b64 a[86:87], v8 offset:1032
    v_mfma_f32_16x16x32_bf16 v[56:59], a[16:19], a[40:43], v[56:59]
    ds_read_b128 a[116:119], v9 offset:2560
    v_mfma_f32_16x16x32_bf16 v[60:63], a[12:15], a[48:51], v[60:63]
    v_mfma_f32_16x16x32_bf16 v[60:63], a[16:19], a[44:47], v[60:63]
    ds_read_b64 a[88:89], v8 offset:512
    s_waitcnt lgkmcnt(15)
    s_nop 0
    v_mfma_f32_16x16x32_bf16 v[52:55], a[0:3], a[52:55], v[52:55]
    ds_read_b64 a[90:91], v8 offset:520
    v_mfma_f32_16x16x32_bf16 v[52:55], a[20:23], a[32:35], v[52:55]
    ds_read_b128 a[120:123], v9 offset:3072
    v_mfma_f32_16x16x32_bf16 v[56:59], a[4:7], a[52:55], v[56:59]
    v_mfma_f32_16x16x32_bf16 v[56:59], a[20:23], a[36:39], v[56:59]
    ds_read_b64 a[92:93], v8 offset:0
    v_mfma_f32_16x16x32_bf16 v[60:63], a[8:11], a[52:55], v[60:63]
    ds_read_b64 a[94:95], v8 offset:8
    v_mfma_f32_16x16x32_bf16 v[60:63], a[20:23], a[40:43], v[60:63]
    ds_read_b128 a[124:127], v9 offset:3584
    v_mfma_f32_16x16x32_bf16 v[56:59], a[0:3], a[56:59], v[56:59]
    v_mfma_f32_16x16x32_bf16 v[56:59], a[24:27], a[32:35], v[56:59]
    v_mfma_f32_16x16x32_bf16 v[60:63], a[4:7], a[56:59], v[60:63]
    v_mfma_f32_16x16x32_bf16 v[60:63], a[24:27], a[36:39], v[60:63]
    v_mfma_f32_16x16x32_bf16 v[60:63], a[0:3], a[60:63], v[60:63]
    v_mfma_f32_16x16x32_bf16 v[60:63], a[28:31], a[32:35], v[60:63]
    v_mfma_f32_16x16x32_bf16 v[32:35], a[64:67], a[96:99], v[32:35]
    s_waitcnt lgkmcnt(15)
    v_mfma_f32_16x16x32_bf16 v[36:39], a[64:67], a[100:103], v[36:39]
    s_nop 0
    v_mfma_f32_16x16x32_bf16 v[36:39], a[68:71], a[96:99], v[36:39]
    v_mfma_f32_16x16x32_bf16 v[40:43], a[68:71], a[100:103], v[40:43]
    v_mfma_f32_16x16x32_bf16 v[40:43], a[64:67], a[104:107], v[40:43]
    v_mfma_f32_16x16x32_bf16 v[40:43], a[72:75], a[96:99], v[40:43]
    v_mfma_f32_16x16x32_bf16 v[44:47], a[68:71], a[104:107], v[44:47]
    v_mfma_f32_16x16x32_bf16 v[44:47], a[72:75], a[100:103], v[44:47]
    v_mfma_f32_16x16x32_bf16 v[48:51], a[72:75], a[104:107], v[48:51]
    s_waitcnt lgkmcnt(12)
    s_nop 0
    v_mfma_f32_16x16x32_bf16 v[44:47], a[64:67], a[108:111], v[44:47]
    v_mfma_f32_16x16x32_bf16 v[44:47], a[76:79], a[96:99], v[44:47]
    v_mfma_f32_16x16x32_bf16 v[48:51], a[68:71], a[108:111], v[48:51]
    v_mfma_f32_16x16x32_bf16 v[48:51], a[76:79], a[100:103], v[48:51]
    v_mfma_f32_16x16x32_bf16 v[52:55], a[72:75], a[108:111], v[52:55]
    v_mfma_f32_16x16x32_bf16 v[52:55], a[76:79], a[104:107], v[52:55]
    v_mfma_f32_16x16x32_bf16 v[56:59], a[76:79], a[108:111], v[56:59]
    s_waitcnt lgkmcnt(9)
    s_nop 0
    v_mfma_f32_16x16x32_bf16 v[48:51], a[64:67], a[112:115], v[48:51]
    v_mfma_f32_16x16x32_bf16 v[48:51], a[80:83], a[96:99], v[48:51]
    v_mfma_f32_16x16x32_bf16 v[52:55], a[68:71], a[112:115], v[52:55]
    v_mfma_f32_16x16x32_bf16 v[52:55], a[80:83], a[100:103], v[52:55]
    v_mfma_f32_16x16x32_bf16 v[56:59], a[72:75], a[112:115], v[56:59]
    v_mfma_f32_16x16x32_bf16 v[56:59], a[80:83], a[104:107], v[56:59]
    v_mfma_f32_16x16x32_bf16 v[60:63], a[76:79], a[112:115], v[60:63]
    v_mfma_f32_16x16x32_bf16 v[60:63], a[80:83], a[108:111], v[60:63]
    s_waitcnt lgkmcnt(6)
    v_mfma_f32_16x16x32_bf16 v[52:55], a[64:67], a[116:119], v[52:55]
    v_mfma_f32_16x16x32_bf16 v[52:55], a[84:87], a[96:99], v[52:55]
    v_mfma_f32_16x16x32_bf16 v[56:59], a[68:71], a[116:119], v[56:59]
    v_mfma_f32_16x16x32_bf16 v[56:59], a[84:87], a[100:103], v[56:59]
    v_mfma_f32_16x16x32_bf16 v[60:63], a[72:75], a[116:119], v[60:63]
    v_mfma_f32_16x16x32_bf16 v[60:63], a[84:87], a[104:107], v[60:63]
    s_waitcnt lgkmcnt(3)
    v_mfma_f32_16x16x32_bf16 v[56:59], a[64:67], a[120:123], v[56:59]
    v_mfma_f32_16x16x32_bf16 v[56:59], a[88:91], a[96:99], v[56:59]
    v_mfma_f32_16x16x32_bf16 v[60:63], a[68:71], a[120:123], v[60:63]
    v_mfma_f32_16x16x32_bf16 v[60:63], a[88:91], a[100:103], v[60:63]
    s_waitcnt lgkmcnt(0)
    v_mfma_f32_16x16x32_bf16 v[60:63], a[64:67], a[124:127], v[60:63]
    v_mfma_f32_16x16x32_bf16 v[60:63], a[92:95], a[96:99], v[60:63]
    s_lshl_b32 s74, s58, 13
    s_add_u32 s74, s74, 0
    v_add_u32 v11, s74, v10
    s_and_b32 s75, s58, 1
    s_lshl_b32 s75, s75, 12
    s_and_b32 s74, s58, 2
    s_lshl_b32 s74, s74, 13
    s_add_u32 s74, s74, s75
    s_add_u32 s74, s74, 0
    v_add_u32 v25, s74, v10
    s_barrier
    ds_write_b128 v11, v[32:35] offset:0
    ds_write_b128 v11, v[36:39] offset:1024
    ds_write_b128 v11, v[40:43] offset:2048
    ds_write_b128 v11, v[44:47] offset:3072
    ds_write_b128 v11, v[48:51] offset:4096
    ds_write_b128 v11, v[52:55] offset:5120
    ds_write_b128 v11, v[56:59] offset:6144
    ds_write_b128 v11, v[60:63] offset:7168
    v_and_b32 v11, 15, v0
    v_lshlrev_b32 v11, 5, v11
    v_bfe_u32 v12, v0, 4, 1
    v_lshl_add_u32 v11, v12, 9, v11
    v_lshrrev_b32_e64 v12, 5, v0
    v_lshl_add_u32 v11, v12, 4, v11
    s_lshl_b32 s74, s94, 12
    s_and_b32 s75, s58, 1
    s_lshl_b32 s75, s75, 11
    s_add_u32 s74, s74, s75
    s_add_u32 s74, s74, 2097152
    s_waitcnt lgkmcnt(0)
    s_barrier
    ds_read_b128 v[64:67], v25 offset:0
    ds_read_b128 v[80:83], v25 offset:8192
    ds_read_b128 v[68:71], v25 offset:1024
    ds_read_b128 v[84:87], v25 offset:9216
    ds_read_b128 v[72:75], v25 offset:2048
    ds_read_b128 v[88:91], v25 offset:10240
    ds_read_b128 v[76:79], v25 offset:3072
    ds_read_b128 v[92:95], v25 offset:11264
    s_waitcnt lgkmcnt(6)
    v_pk_add_f32 v[64:65], v[64:65], v[80:81]
    v_pk_add_f32 v[66:67], v[66:67], v[82:83]
    s_waitcnt lgkmcnt(4)
    v_pk_add_f32 v[68:69], v[68:69], v[84:85]
    v_pk_add_f32 v[70:71], v[70:71], v[86:87]
    s_waitcnt lgkmcnt(2)
    v_pk_add_f32 v[72:73], v[72:73], v[88:89]
    v_pk_add_f32 v[74:75], v[74:75], v[90:91]
    s_waitcnt lgkmcnt(0)
    v_pk_add_f32 v[76:77], v[76:77], v[92:93]
    v_pk_add_f32 v[78:79], v[78:79], v[94:95]
    v_cvt_pk_bf16_f32 v96, v64, v65
    v_cvt_pk_bf16_f32 v97, v66, v67
    v_cvt_pk_bf16_f32 v98, v68, v69
    v_cvt_pk_bf16_f32 v99, v70, v71
    v_cvt_pk_bf16_f32 v100, v72, v73
    v_cvt_pk_bf16_f32 v101, v74, v75
    v_cvt_pk_bf16_f32 v102, v76, v77
    v_cvt_pk_bf16_f32 v103, v78, v79
    v_permlane16_swap_b32 v96, v98
    v_permlane16_swap_b32 v97, v99
    v_permlane16_swap_b32 v100, v102
    v_permlane16_swap_b32 v101, v103
    buffer_store_dwordx4 v[96:99], v11, s[36:39], s74 offen offset:0 sc0 sc1
    buffer_store_dwordx4 v[100:103], v11, s[36:39], s74 offen offset:1024 sc0 sc1
    v_and_b32 v11, 15, v0
    v_lshrrev_b32 v12, 4, v0
    s_lshl_b32 s74, s89, 6
    s_lshl_b32 s75, s58, 4
    s_add_u32 s74, s74, s75
    v_add_u32_e64 v7, s74, v11
    v_mul_u32_u24 v14, 896, v7
    v_lshl_add_u32 v14, v12, 4, v14
    s_lshl_b32 s75, s90, 7
    buffer_load_dwordx4 v[40:43], v14, s[40:43], s75 offen
    buffer_load_dwordx4 v[44:47], v14, s[40:43], s75 offen offset:64
    v_lshlrev_b32_e64 v15, 4, v12
    buffer_load_dwordx4 v[48:51], v15, s[48:51], s75 offen
    buffer_load_dwordx4 v[52:55], v15, s[48:51], s75 offen offset:64
    s_waitcnt vmcnt(4)
    s_barrier
    s_cmp_lg_u32 s58, 0
    s_cbranch_scc1 L_pw9
    s_lshl_b32 s75, s3, 2
    s_add_u32 s75, s75, 13959168
    v_mov_b32 v28, s80
    v_mov_b32 v29, s75
    s_mov_b64 exec, 1
    buffer_store_dword v28, v29, s[36:39], 0 offen sc0 sc1
    s_mov_b64 exec, -1
L_pw9:
    s_lshl_b32 s75, s90, 7
    s_add_u32 s75, s75, 13959168
    v_and_b32 v27, 31, v0
    v_lshlrev_b32 v27, 2, v27
    v_add_u32 v27, s75, v27
    s_sleep 32
    s_waitcnt vmcnt(0)
    s_cmp_lg_u32 s58, 0
    s_cbranch_scc1 L_p010_done
    s_mov_b32 s76, 400000
L_p010:
    buffer_load_dword v26, v27, s[36:39], 0 offen sc0 sc1
    s_waitcnt vmcnt(0)
    v_cmp_ne_u32 vcc, s80, v26
    s_nop 1
    s_cbranch_vccz L_p010_done
    s_sleep 16
    s_sub_u32 s76, s76, 1
    s_cmp_lg_u32 s76, 0
    s_cbranch_scc1 L_p010
L_p010_done:
    s_barrier
    s_and_b32 s74, s3, 31
    s_or_b32 s74, s74, s58
    s_cmp_lg_u32 s74, 0
    s_cbranch_scc1 L_nobumpB
    s_lshl_b32 s75, s90, 7
    s_add_u32 s75, s75, 7341056
    v_mov_b32 v28, s80
    v_mov_b32 v29, s75
    s_mov_b64 exec, 1
    buffer_store_dword v28, v29, s[36:39], 0 offen sc0 sc1
    s_mov_b64 exec, -1
L_nobumpB:
    v_lshrrev_b32 v11, 3, v0
    v_lshlrev_b32 v11, 12, v11
    v_and_b32 v12, 7, v0
    v_lshl_add_u32 v11, v12, 4, v11
    s_lshl_b32 s74, s90, 18
    s_lshl_b32 s75, s58, 16
    s_add_u32 s74, s74, s75
    s_lshl_b32 s75, s89, 7
    s_add_u32 s74, s74, s75
    s_add_u32 s74, s74, 2097152
    s_lshl_b32 s75, s58, 11
    s_add_u32 s75, s75, 0
    s_add_u32 m0, s75, 0
    s_nop 0
    buffer_load_dwordx4 v11, s[36:39], s74 offen sc0 sc1 lds
    s_add_u32 s74, s74, 32768
    s_add_u32 m0, s75, 1024
    s_nop 0
    buffer_load_dwordx4 v11, s[36:39], s74 offen sc0 sc1 lds
    v_and_b32 v11, 15, v0
    v_lshrrev_b32 v12, 4, v0
    v_lshrrev_b32_e64 v14, 2, v11
    v_lshl_add_u32 v15, v12, 3, v14
    v_lshlrev_b32 v15, 7, v15
    v_and_b32 v20, 3, v11
    v_lshl_add_u32 v15, v20, 3, v15
    s_lshl_b32 s74, s58, 5
    s_add_u32 s74, s74, 0
    v_add_u32_e64 v15, s74, v15
    s_waitcnt vmcnt(0)
    s_barrier
    ds_read_b64_tr_b16 v[32:33], v15 offset:0
    ds_read_b64_tr_b16 v[34:35], v15 offset:512
    ds_read_b64_tr_b16 v[36:37], v15 offset:4096
    ds_read_b64_tr_b16 v[38:39], v15 offset:4608
    v_lshlrev_b32 v56, 16, v40
    v_and_b32 v57, s93, v40
    v_lshlrev_b32 v58, 16, v48
    v_and_b32 v59, s93, v48
    v_pk_mul_f32 v[56:57], v[56:57], v[58:59]
    s_waitcnt lgkmcnt(3)
    v_lshlrev_b32 v58, 16, v32
    v_and_b32 v59, s93, v32
    v_cvt_pk_bf16_f32 v56, v56, v57
    v_and_b32 v57, s93, v56
    v_lshlrev_b32 v56, 16, v56
    v_pk_add_f32 v[56:57], v[56:57], v[58:59]
    v_cvt_pk_bf16_f32 v60, v56, v57
    v_lshlrev_b32 v56, 16, v41
    v_and_b32 v57, s93, v41
    v_lshlrev_b32 v58, 16, v49
    v_and_b32 v59, s93, v49
    v_pk_mul_f32 v[56:57], v[56:57], v[58:59]
    v_lshlrev_b32 v58, 16, v33
    v_and_b32 v59, s93, v33
    v_cvt_pk_bf16_f32 v56, v56, v57
    v_and_b32 v57, s93, v56
    v_lshlrev_b32 v56, 16, v56
    v_pk_add_f32 v[56:57], v[56:57], v[58:59]
    v_cvt_pk_bf16_f32 v61, v56, v57
    v_lshlrev_b32 v56, 16, v42
    v_and_b32 v57, s93, v42
    v_lshlrev_b32 v58, 16, v50
    v_and_b32 v59, s93, v50
    v_pk_mul_f32 v[56:57], v[56:57], v[58:59]
    s_waitcnt lgkmcnt(2)
    v_lshlrev_b32 v58, 16, v34
    v_and_b32 v59, s93, v34
    v_cvt_pk_bf16_f32 v56, v56, v57
    v_and_b32 v57, s93, v56
    v_lshlrev_b32 v56, 16, v56
    v_pk_add_f32 v[56:57], v[56:57], v[58:59]
    v_cvt_pk_bf16_f32 v62, v56, v57
    v_lshlrev_b32 v56, 16, v43
    v_and_b32 v57, s93, v43
    v_lshlrev_b32 v58, 16, v51
    v_and_b32 v59, s93, v51
    v_pk_mul_f32 v[56:57], v[56:57], v[58:59]
    v_lshlrev_b32 v58, 16, v35
    v_and_b32 v59, s93, v35
    v_cvt_pk_bf16_f32 v56, v56, v57
    v_and_b32 v57, s93, v56
    v_lshlrev_b32 v56, 16, v56
    v_pk_add_f32 v[56:57], v[56:57], v[58:59]
    v_cvt_pk_bf16_f32 v63, v56, v57
    v_lshlrev_b32 v56, 16, v44
    v_and_b32 v57, s93, v44
    v_lshlrev_b32 v58, 16, v52
    v_and_b32 v59, s93, v52
    v_pk_mul_f32 v[56:57], v[56:57], v[58:59]
    s_waitcnt lgkmcnt(1)
    v_lshlrev_b32 v58, 16, v36
    v_and_b32_e64 v59, s93, v36
    v_cvt_pk_bf16_f32 v56, v56, v57
    v_and_b32 v57, s93, v56
    v_lshlrev_b32 v56, 16, v56
    v_pk_add_f32 v[56:57], v[56:57], v[58:59]
    v_cvt_pk_bf16_f32 v64, v56, v57
    v_lshlrev_b32 v56, 16, v45
    v_and_b32 v57, s93, v45
    v_lshlrev_b32 v58, 16, v53
    v_and_b32 v59, s93, v53
    v_pk_mul_f32 v[56:57], v[56:57], v[58:59]
    v_lshlrev_b32 v58, 16, v37
    v_and_b32 v59, s93, v37
    v_cvt_pk_bf16_f32 v56, v56, v57
    v_and_b32 v57, s93, v56
    v_lshlrev_b32 v56, 16, v56
    v_pk_add_f32 v[56:57], v[56:57], v[58:59]
    v_cvt_pk_bf16_f32 v65, v56, v57
    v_lshlrev_b32 v56, 16, v46
    v_and_b32 v57, s93, v46
    v_lshlrev_b32 v58, 16, v54
    v_and_b32 v59, s93, v54
    v_pk_mul_f32 v[56:57], v[56:57], v[58:59]
    s_waitcnt lgkmcnt(0)
    v_lshlrev_b32 v58, 16, v38
    v_and_b32 v59, s93, v38
    v_cvt_pk_bf16_f32 v56, v56, v57
    v_and_b32 v57, s93, v56
    v_lshlrev_b32_e64 v56, 16, v56
    v_pk_add_f32 v[56:57], v[56:57], v[58:59]
    v_cvt_pk_bf16_f32 v66, v56, v57
    v_lshlrev_b32 v56, 16, v47
    v_and_b32 v57, s93, v47
    v_lshlrev_b32 v58, 16, v55
    v_and_b32 v59, s93, v55
    v_pk_mul_f32 v[56:57], v[56:57], v[58:59]
    v_lshlrev_b32 v58, 16, v39
    v_and_b32 v59, s93, v39
    v_cvt_pk_bf16_f32 v56, v56, v57
    v_and_b32 v57, s93, v56
    v_lshlrev_b32 v56, 16, v56
    v_pk_add_f32 v[56:57], v[56:57], v[58:59]
    v_cvt_pk_bf16_f32 v67, v56, v57
    v_mul_u32_u24 v14, 1792, v7
    v_lshl_add_u32 v14, v12, 4, v14
    s_lshl_b32 s75, s90, 7
    s_add_u32 s75, s75, 896
    buffer_store_dwordx4 v[60:63], v14, s[52:55], s75 offen nt
    buffer_store_dwordx4 v[64:67], v14, s[52:55], s75 offen offset:64 nt
    s_waitcnt vmcnt(0)
    s_endpgm
L_end:
    s_endpgm
L_code_end:
.section .rodata,"a"
.p2align 6
.amdhsa_kernel concat_heads__linear_kernel_hedgehog__ssm_conv_s4d__prompt_kernel
  .amdhsa_next_free_vgpr 256
  .amdhsa_next_free_sgpr 102
  .amdhsa_accum_offset 128
  .amdhsa_group_segment_fixed_size 0
  .amdhsa_kernarg_size 112
  .amdhsa_user_sgpr_count 2
  .amdhsa_user_sgpr_kernarg_segment_ptr 1
  .amdhsa_system_sgpr_workgroup_id_x 1
  .amdhsa_float_denorm_mode_32 3
.end_amdhsa_kernel
```
